```python
import torch

def _softmax(x, axis=-1):
    return torch.softmax(x, dim=axis)
def _gelu(x):
    return torch.nn.functional.gelu(x, approximate="tanh")
def _silu(x):
    return torch.nn.functional.silu(x)
def _sigmoid(x):
    return torch.sigmoid(x)
def _layernorm(x, axis=-1, eps=1e-5):
    m = x.mean(dim=axis, keepdim=True)
    v = x.var(dim=axis, keepdim=True, unbiased=False)
    return (x - m) / torch.sqrt(v + eps)
def _scatter_add(tgt, idx, src, axis=0):
    return tgt.clone().index_add_(axis, idx, src)
def _segment_sum(src, seg, n):
    out = torch.zeros((n,) + src.shape[1:], dtype=src.dtype)
    return out.index_add_(0, seg, src)
def _pad(x, pw):
    flat = tuple(v for pair in reversed(pw) for v in pair)
    return torch.nn.functional.pad(x, flat)

kernel_name = 'sequential_preLN__sliding_local_dilated__mixer_token_mlp__prompt'

def setup_inputs():

    _w = (lambda a: (lambda t: t.to(torch.bfloat16) if t.is_floating_point() else t)(torch.as_tensor(a)))
    def _A_setup():
        B, S, D = 1, 2048, 640
        return {
            "x": _w((lambda *s: torch.randn(*s, dtype=torch.bfloat16) * 0.05)(B, S, D)),
            "wqkv": _w((lambda *s: torch.randn(*s, dtype=torch.bfloat16) * 0.05)(D, 3 * D)),
            "wo": _w((lambda *s: torch.randn(*s, dtype=torch.bfloat16) * 0.05)(D, D)),
        }
    _A_in = _A_setup()

    def _B_setup():
        B, S, D, F = 1, 2048, 640, 1536
        return {
            "x": _w((lambda *s: torch.randn(*s, dtype=torch.bfloat16) * 0.05)(B, S, D)),
            "w1": _w((lambda *s: torch.randn(*s, dtype=torch.bfloat16) * 0.8)(S, F) * (S ** -0.5)),
            "b1": _w((lambda *s: torch.randn(*s, dtype=torch.bfloat16) * 0.8)(F) * 0.02),
            "w2": _w((lambda *s: torch.randn(*s, dtype=torch.bfloat16) * 0.8)(F, S) * (F ** -0.5)),
            "b2": _w((lambda *s: torch.randn(*s, dtype=torch.bfloat16) * 0.8)(S) * 0.02),
        }
    _B_in = _B_setup()

    return {
        "A_x": _A_in["x"],
        "A_wqkv": _A_in["wqkv"],
        "A_wo": _A_in["wo"],
        "B_x": _B_in["x"],
        "B_w1": _B_in["w1"],
        "B_b1": _B_in["b1"],
        "B_w2": _B_in["w2"],
        "B_b2": _B_in["b2"],
    }

def reference(A_x, A_wqkv, A_wo, B_x, B_w1, B_b1, B_w2, B_b2):
    def _A_ref(x, wqkv, wo):
        B, S, D = x.shape
        H = 32; Dh = D // H
        W, dil = 8, 2
        qkv = (lambda x, *d: x.permute(*d))((x @ wqkv).reshape(B, S, 3, H, Dh), 2, 0, 3, 1, 4)
        q, k, v = qkv[0], qkv[1], qkv[2]
        scale = Dh ** -0.5
        pos = torch.arange(S)
        off = torch.arange(W) * dil
        idx = pos[:, None] - off[None, :]
        mask = idx >= 0
        idx_c = torch.where(mask, idx, 0).reshape(-1)
        kg = k[:, :, idx_c, :].reshape(B, H, S, W, Dh)
        vg = v[:, :, idx_c, :].reshape(B, H, S, W, Dh)
        logits = torch.einsum("bhsd,bhswd->bhsw", q, kg) * scale
        logits = torch.where(mask[None, None, :, :], logits, -1e9)
        attn = _softmax(logits, axis=-1)
        o = torch.einsum("bhsw,bhswd->bhsd", attn, vg)
        return (lambda x, *d: x.permute(*d))(o, 0, 2, 1, 3).reshape(B, S, D) @ wo

    def _B_ref(x, w1, b1, w2, b2):
        B, S, D = x.shape
        h = _layernorm(x, axis=-1)
        u = torch.einsum("bsd,sf->bdf", h, w1) + b1
        u = _gelu(u)
        y = torch.einsum("bdf,fs->bds", u, w2) + b2
        return (lambda x, *d: x.permute(*d))(y, 0, 2, 1)

    x = A_x
    h = x + _A_ref(_layernorm(x, axis=-1), A_wqkv, A_wo)
    h2 = h + _B_ref(_layernorm(h, axis=-1), B_w1, B_b1, B_w2, B_b2)
    return h2
```

```asm
; @launch grid=(256,1,1) block=(768,1,1) lds=163840
.amdgcn_target "amdgcn-amd-amdhsa--gfx950"
.text
.globl sequential_preLN__sliding_local_dilated__mixer_token_mlp__prompt_kernel
.p2align 8
.type sequential_preLN__sliding_local_dilated__mixer_token_mlp__prompt_kernel,@function
sequential_preLN__sliding_local_dilated__mixer_token_mlp__prompt_kernel:
  s_cmp_ge_u32 s2, 256
  s_cbranch_scc1 K_END
  s_load_dwordx16 s[72:87], s[0:1], 0
  s_load_dwordx4 s[88:91], s[0:1], 64
  s_load_dwordx2 s[92:93], s[0:1], 80
  v_lshrrev_b32 v5, 6, v0
  v_and_b32 v1, 63, v0
  v_readfirstlane_b32 s24, v5
  s_nop 1
  s_add_u32 s3, s24, 8
  s_sub_u32 s24, s24, 4
  s_cselect_b32 s24, s3, s24
  v_and_b32 v2, 15, v0
  v_bfe_u32 v3, v0, 4, 2
  v_lshlrev_b32 v4, 4, v1
  s_and_b32 s25, s2, 7
  s_lshr_b32 s26, s2, 3
  s_cmp_ge_u32 s24, 8
  s_cbranch_scc1 HELPER
  s_lshr_b32 s27, s25, 1
  s_lshl_b32 s27, s27, 2
  s_lshr_b32 s28, s26, 3
  s_add_u32 s27, s27, s28
  s_and_b32 s40, s25, 1
  s_lshl_b32 s40, s40, 3
  s_and_b32 s28, s26, 7
  s_mul_i32 s66, s28, 160
  s_add_u32 s28, s28, s40
  s_lshr_b32 s29, s24, 2
  s_and_b32 s30, s24, 3
  s_lshr_b32 s40, s25, 1
  s_lshl_b32 s40, s40, 5
  s_add_u32 s40, s40, s26
  s_lshl_b32 s40, s40, 4
  v_add_u32 v5, s40, v2
  v_mul_u32_u24 v5, 1280, v5
  v_lshl_add_u32 v12, v3, 7, v5
  v_cmp_le_u32 vcc, 30, v1
  s_nop 1
  v_cndmask_b32 v5, 0, 1, vcc
  v_mul_u32_u24 v6, 30, v5
  v_sub_u32 v6, v1, v6
  v_cmp_le_u32 vcc, 15, v6
  s_nop 1
  v_cndmask_b32 v7, 0, 1, vcc
  v_lshl_add_u32 v5, v5, 6, v7
  s_lshl_b32 s40, s26, 1
  v_add_u32 v5, s40, v5
  v_mul_u32_u24 v5, 3840, v5
  v_mul_u32_u24 v7, 15, v7
  v_sub_u32 v6, v6, v7
  v_mul_u32_u24 v7, 13, v6
  v_lshrrev_b32 v7, 6, v7
  v_mul_u32_u24 v8, 640, v7
  v_lshl_add_u32 v8, v6, 7, v8
  s_and_b32 s40, s25, 1
  s_mul_i32 s40, s40, 640
  v_add3_u32 v5, v5, v8, s40
  v_mov_b32 v6, 0x80000000
  v_cmp_gt_u32 vcc, 60, v1
  s_nop 1
  v_cndmask_b32 v5, v6, v5, vcc
  s_mul_i32 s40, s24, 11
  s_lshr_b32 s40, s40, 5
  s_mul_i32 s55, s40, 3
  s_lshl_b32 s64, s40, 9
  s_sub_u32 s31, s24, s40
  s_sub_u32 s31, s31, 1
  s_mul_i32 s31, s31, 491520
  s_cmp_eq_u32 s55, s24
  s_cselect_b64 s[42:43], -1, 0
  s_cselect_b32 s64, s64, s31
  v_cndmask_b32 v12, v5, v12, s[42:43]
  s_mov_b32 s32, 0
  s_mov_b32 s33, 35840
  s_mov_b32 s34, 71680
  s_waitcnt lgkmcnt(0)
  s_cmp_lg_u64 s[42:43], 0
  s_cselect_b32 s8, s72, s74
  s_cselect_b32 s9, s73, s75
  s_mov_b32 s10, 2457600
  s_cselect_b32 s10, 2621440, s10
  s_mov_b32 s11, 0x00020000
  s_cmp_ge_u32 s24, 5
  s_cbranch_scc1 P1_NOPFA
  buffer_load_dword v9, v12, s[8:11], s64 offen
P1_NOPFA:
  s_mov_b32 s16, s92
  s_mov_b32 s17, s93
  s_mov_b32 s18, 2621440
  s_mov_b32 s19, 0x00020000
  v_mov_b32 v108, 0x3f803f80
  v_mov_b32 v109, 0x3f803f80
  v_mov_b32 v110, 0x3f803f80
  v_mov_b32 v111, 0x3f803f80
  v_mov_b32 v8, 150272
  ds_write_b128 v8, v[108:111]
  s_mul_i32 s40, s29, 10240
  v_lshrrev_b32 v5, 1, v2
  v_xor_b32 v5, v5, v3
  v_lshlrev_b32 v5, 4, v5
  v_lshl_add_u32 v5, v2, 7, v5
  v_add_u32 v5, s40, v5
  s_cmp_eq_u32 s29, 0
  s_cselect_b64 s[42:43], -1, 0
  s_xor_b32 s40, s30, 0
  s_lshl_b32 s40, s40, 11
  v_add_u32 v13, s40, v5
  v_xor_b32 v18, 64, v13
  s_xor_b32 s40, s30, 1
  s_lshl_b32 s40, s40, 11
  v_add_u32 v14, s40, v5
  v_xor_b32 v19, 64, v14
  s_xor_b32 s40, s30, 2
  s_lshl_b32 s40, s40, 11
  v_add_u32 v15, s40, v5
  v_xor_b32 v20, 64, v15
  s_xor_b32 s40, s30, 3
  s_lshl_b32 s40, s40, 11
  v_add_u32 v16, s40, v5
  v_xor_b32 v21, 64, v16
  v_add_u32 v6, 8192, v5
  v_xor_b32 v7, 64, v6
  v_cndmask_b32 v17, v8, v6, s[42:43]
  v_cndmask_b32 v22, v8, v7, s[42:43]
  v_bfe_u32 v5, v1, 2, 2
  v_and_b32 v6, 1, v3
  v_lshl_or_b32 v6, v6, 2, v5
  v_lshl_add_u32 v5, v3, 3, v5
  v_lshlrev_b32 v5, 8, v5
  v_and_b32 v7, 3, v1
  v_lshl_add_u32 v5, v7, 3, v5
  v_add_u32 v5, 18432, v5
  s_lshl_b32 s40, s30, 1
  v_xor_b32 v6, s40, v6
  v_lshl_add_u32 v23, v6, 5, v5
  v_xor_b32 v24, 32, v23
  v_mov_b32 v64, 0
  v_mov_b32 v68, 0
  v_mov_b32 v124, 0
  v_mov_b32 v65, 0
  v_mov_b32 v69, 0
  v_mov_b32 v125, 0
  v_mov_b32 v66, 0
  v_mov_b32 v70, 0
  v_mov_b32 v126, 0
  v_mov_b32 v67, 0
  v_mov_b32 v71, 0
  v_mov_b32 v127, 0
  v_mov_b32 v72, 0
  v_mov_b32 v76, 0
  v_mov_b32 v128, 0
  v_mov_b32 v73, 0
  v_mov_b32 v77, 0
  v_mov_b32 v129, 0
  v_mov_b32 v74, 0
  v_mov_b32 v78, 0
  v_mov_b32 v130, 0
  v_mov_b32 v75, 0
  v_mov_b32 v79, 0
  v_mov_b32 v131, 0
  v_mov_b32 v80, 0
  v_mov_b32 v84, 0
  v_mov_b32 v132, 0
  v_mov_b32 v81, 0
  v_mov_b32 v85, 0
  v_mov_b32 v133, 0
  v_mov_b32 v82, 0
  v_mov_b32 v86, 0
  v_mov_b32 v134, 0
  v_mov_b32 v83, 0
  v_mov_b32 v87, 0
  v_mov_b32 v135, 0
  v_mov_b32 v88, 0
  v_mov_b32 v92, 0
  v_mov_b32 v136, 0
  v_mov_b32 v89, 0
  v_mov_b32 v93, 0
  v_mov_b32 v137, 0
  v_mov_b32 v90, 0
  v_mov_b32 v94, 0
  v_mov_b32 v138, 0
  v_mov_b32 v91, 0
  v_mov_b32 v95, 0
  v_mov_b32 v139, 0
  v_mov_b32 v96, 0
  v_mov_b32 v100, 0
  v_mov_b32 v140, 0
  v_mov_b32 v97, 0
  v_mov_b32 v101, 0
  v_mov_b32 v141, 0
  v_mov_b32 v98, 0
  v_mov_b32 v102, 0
  v_mov_b32 v142, 0
  v_mov_b32 v99, 0
  v_mov_b32 v103, 0
  v_mov_b32 v143, 0
  v_mov_b32 v152, 0
  v_mov_b32 v156, 0
  v_mov_b32 v56, 0
  v_mov_b32 v60, 0
  v_mov_b32 v153, 0
  v_mov_b32 v157, 0
  v_mov_b32 v57, 0
  v_mov_b32 v61, 0
  v_mov_b32 v154, 0
  v_mov_b32 v158, 0
  v_mov_b32 v58, 0
  v_mov_b32 v62, 0
  v_mov_b32 v155, 0
  v_mov_b32 v159, 0
  v_mov_b32 v59, 0
  v_mov_b32 v63, 0
  s_cmp_lt_u32 s24, 5
  s_cbranch_scc1 P1_NOPFB
  buffer_load_dword v9, v12, s[8:11], s64 offen
P1_NOPFB:
  s_mov_b32 s8, s80
  s_mov_b32 s9, s81
  s_mov_b32 s10, 6291456
  s_mov_b32 s11, 0x00020000
  s_mov_b32 s12, s84
  s_mov_b32 s13, s85
  s_mov_b32 s14, 6291456
  s_mov_b32 s15, 0x00020000
  s_mov_b32 s20, s76
  s_mov_b32 s21, s77
  s_mov_b32 s22, 819200
  s_mov_b32 s23, 0x00020000
  v_lshlrev_b32 v12, 7, v1
  s_mul_i32 s38, s2, 24576
  s_lshl_b32 s40, s24, 12
  s_add_u32 s38, s38, s40
  s_add_u32 s39, s24, 1
  s_cmp_ge_u32 s24, 6
  s_cselect_b32 s39, 99, s39
  s_cmp_lg_u32 s24, 6
  s_cbranch_scc1 P1_NOWOU
  s_mul_i32 s40, s2, 3200
  s_mov_b64 exec, 0x1ffffff
  buffer_load_dword v9, v12, s[20:23], s40 offen
  s_mov_b64 exec, -1
P1_NOWOU:
  v_and_b32 v7, 1, v2
  v_cmp_eq_u32 s[44:45], 1, v7
  v_lshl_add_u32 v7, v3, 2, v7
  v_cmp_le_u32 s[46:47], v7, v2
  v_add_u32 v7, 2, v7
  v_cmp_le_u32 s[48:49], v7, v2
  v_cmp_eq_u32 s[50:51], 0, v3
  v_cmp_eq_u32 s[58:59], 2, v3
  v_and_b32 v7, 2, v2
  v_cmp_ne_u32 s[6:7], 0, v7
  v_lshrrev_b32 v7, 2, v2
  v_cmp_eq_u32 s[56:57], v7, v3
  s_mul_i32 s40, s29, 640
  s_add_u32 s40, s40, 148480
  v_lshlrev_b32 v5, 3, v2
  v_add_u32 v5, s40, v5
  s_mul_i32 s40, s29, 21760
  s_lshl_b32 s55, s30, 6
  s_add_u32 s40, s40, s55
  v_mul_u32_u24 v7, 272, v2
  v_lshl_add_u32 v7, v3, 3, v7
  v_add_u32 v7, s40, v7
  s_xor_b32 s40, s30, 0
  s_lshl_b32 s55, s40, 7
  v_add_u32 v39, s55, v5
  s_mul_i32 s55, s40, 4352
  v_add_u32 v44, s55, v7
  s_xor_b32 s40, s30, 1
  s_lshl_b32 s55, s40, 7
  v_add_u32 v40, s55, v5
  s_mul_i32 s55, s40, 4352
  v_add_u32 v45, s55, v7
  s_xor_b32 s40, s30, 2
  s_lshl_b32 s55, s40, 7
  v_add_u32 v41, s55, v5
  s_mul_i32 s55, s40, 4352
  v_add_u32 v46, s55, v7
  s_xor_b32 s40, s30, 3
  s_lshl_b32 s55, s40, 7
  v_add_u32 v42, s55, v5
  s_mul_i32 s55, s40, 4352
  v_add_u32 v47, s55, v7
  v_add_u32 v43, 512, v5
  v_add_u32 v48, 17408, v7
  s_lshl_b32 s40, s30, 7
  s_add_u32 s40, s40, 149760
  v_lshlrev_b32 v7, 4, v3
  v_add_u32 v49, s40, v7
  s_cmp_eq_u32 s29, 0
  s_cselect_b32 s40, 150336, s40
  v_add_u32 v50, s40, v7
  s_and_b32 s42, s24, 1
  s_lshr_b32 s43, s24, 1
  s_lshl_b32 s43, s43, 1
  s_mul_i32 s40, s43, 4352
  s_mul_i32 s55, s42, 40
  s_add_u32 s40, s40, s55
  v_mul_u32_u24 v5, 272, v2
  v_add_u32 v33, s40, v5
  v_lshl_add_u32 v32, v3, 3, v33
  v_bfe_u32 v5, v1, 2, 2
  v_lshl_add_u32 v5, v3, 2, v5
  v_mul_u32_u24 v5, 272, v5
  v_and_b32 v6, 3, v1
  v_lshl_add_u32 v5, v6, 3, v5
  v_add_u32 v34, s40, v5
  s_mul_i32 s40, s43, 1280
  s_mul_i32 s55, s42, 40
  s_add_u32 s40, s40, s55
  s_add_u32 s40, s40, 151040
  v_mul_u32_u24 v5, 80, v2
  v_add_u32 v5, s40, v5
  v_lshl_add_u32 v35, v3, 3, v5
  v_add_u32 v5, 32, v5
  v_mov_b32 v6, 161280
  v_cndmask_b32 v36, v6, v5, s[50:51]
  s_lshl_b32 s40, s24, 6
  v_add_u32 v5, s40, v1
  v_and_b32 v6, 127, v5
  v_lshrrev_b32 v7, 7, v5
  v_mul_u32_u24 v8, 80, v6
  v_lshl_add_u32 v8, v7, 4, v8
  v_add_u32 v51, 151040, v8
  v_mul_u32_u24 v8, 80, v6
  v_add_u32 v52, 151104, v8
  v_lshrrev_b32 v8, 4, v6
  v_mul_u32_u24 v8, 20480, v8
  v_and_b32 v6, 15, v6
  v_lshl_add_u32 v8, v6, 4, v8
  s_mul_i32 s40, s28, 5
  v_add_u32 v7, s40, v7
  v_lshrrev_b32 v6, 2, v7
  v_lshl_add_u32 v6, v6, 10, v8
  v_and_b32 v5, 3, v7
  v_lshl_add_u32 v53, v5, 8, v6
  s_add_u32 s40, s40, 4
  v_mov_b32 v7, s40
  v_lshrrev_b32 v6, 2, v7
  v_lshl_add_u32 v6, v6, 10, v8
  v_and_b32 v5, 3, v7
  v_lshl_add_u32 v54, v5, 8, v6
  v_mov_b32 v5, 0xffff
  v_mov_b32 v6, 0xffff0000
  v_cndmask_b32 v37, v5, v6, s[44:45]
  s_or_b32 s40, s27, s43
  s_cmp_lg_u32 s40, 0
  s_cselect_b64 s[52:53], -1, 0
  s_mov_b32 s54, 0x3ea52b5c
  s_mul_i32 s35, s27, 163840
  v_mov_b32 v38, 0xff800000
  s_mov_b32 s31, 0
P1_LOOP:
  s_waitcnt lgkmcnt(0)
  s_barrier
  s_cmp_eq_u32 s29, 0
  s_cselect_b32 s41, s32, 0
  v_add_u32 v30, s32, v23
  v_add_u32 v31, s32, v24
  v_add_u32 v25, s32, v13
  v_add_u32 v26, s32, v14
  v_add_u32 v27, s32, v15
  v_add_u32 v28, s32, v16
  v_add_u32 v29, s41, v17
  ds_read_b64_tr_b16 v[144:145], v30 offset:0
  ds_read_b64_tr_b16 v[146:147], v30 offset:1024
  ds_read_b64_tr_b16 v[148:149], v31 offset:0
  ds_read_b64_tr_b16 v[150:151], v31 offset:1024
  ds_read_b128 v[104:107], v25
  ds_read_b128 v[108:111], v26
  ds_read_b128 v[112:115], v27
  ds_read_b128 v[116:119], v28
  ds_read_b128 v[120:123], v29
  v_add_u32 v25, s32, v18
  v_add_u32 v26, s32, v19
  v_add_u32 v27, s32, v20
  v_add_u32 v28, s32, v21
  v_add_u32 v29, s41, v22
  v_mfma_f32_16x16x32_bf16 v[64:67], v[152:155], v[124:127], v[64:67]
  v_mfma_f32_16x16x32_bf16 v[68:71], v[156:159], v[124:127], v[68:71]
  v_mfma_f32_16x16x32_bf16 v[56:59], v[124:127], v[124:127], v[56:59]
  v_mfma_f32_16x16x32_bf16 v[72:75], v[152:155], v[128:131], v[72:75]
  v_mfma_f32_16x16x32_bf16 v[76:79], v[156:159], v[128:131], v[76:79]
  v_mfma_f32_16x16x32_bf16 v[80:83], v[152:155], v[132:135], v[80:83]
  v_mfma_f32_16x16x32_bf16 v[84:87], v[156:159], v[132:135], v[84:87]
  v_mfma_f32_16x16x32_bf16 v[88:91], v[152:155], v[136:139], v[88:91]
  v_mfma_f32_16x16x32_bf16 v[92:95], v[156:159], v[136:139], v[92:95]
  v_mfma_f32_16x16x32_bf16 v[96:99], v[152:155], v[140:143], v[96:99]
  v_mfma_f32_16x16x32_bf16 v[100:103], v[156:159], v[140:143], v[100:103]
  v_mfma_f32_16x16x32_bf16 v[60:63], v[140:143], v[140:143], v[60:63]
  ds_read_b64_tr_b16 v[152:153], v30 offset:8192
  ds_read_b64_tr_b16 v[154:155], v30 offset:9216
  ds_read_b64_tr_b16 v[156:157], v31 offset:8192
  ds_read_b64_tr_b16 v[158:159], v31 offset:9216
  ds_read_b128 v[124:127], v25
  ds_read_b128 v[128:131], v26
  s_waitcnt lgkmcnt(14)
  ds_read_b128 v[132:135], v27
  s_waitcnt lgkmcnt(14)
  ds_read_b128 v[136:139], v28
  s_waitcnt lgkmcnt(14)
  ds_read_b128 v[140:143], v29
  s_cmp_eq_u32 s31, s39
  s_cbranch_scc1 P1_WARM
P1_WARMR:
  s_waitcnt lgkmcnt(13)
  v_mfma_f32_16x16x32_bf16 v[64:67], v[144:147], v[104:107], v[64:67]
  v_mfma_f32_16x16x32_bf16 v[68:71], v[148:151], v[104:107], v[68:71]
  v_mfma_f32_16x16x32_bf16 v[56:59], v[104:107], v[104:107], v[56:59]
  s_waitcnt lgkmcnt(12)
  v_mfma_f32_16x16x32_bf16 v[72:75], v[144:147], v[108:111], v[72:75]
  v_mfma_f32_16x16x32_bf16 v[76:79], v[148:151], v[108:111], v[76:79]
  s_waitcnt lgkmcnt(11)
  v_mfma_f32_16x16x32_bf16 v[80:83], v[144:147], v[112:115], v[80:83]
  v_mfma_f32_16x16x32_bf16 v[84:87], v[148:151], v[112:115], v[84:87]
  s_waitcnt lgkmcnt(10)
  v_mfma_f32_16x16x32_bf16 v[88:91], v[144:147], v[116:119], v[88:91]
  v_mfma_f32_16x16x32_bf16 v[92:95], v[148:151], v[116:119], v[92:95]
  s_waitcnt lgkmcnt(9)
  v_mfma_f32_16x16x32_bf16 v[96:99], v[144:147], v[120:123], v[96:99]
  v_mfma_f32_16x16x32_bf16 v[100:103], v[148:151], v[120:123], v[100:103]
  v_mfma_f32_16x16x32_bf16 v[60:63], v[120:123], v[120:123], v[60:63]
  s_mov_b32 s3, s32
  s_mov_b32 s32, s33
  s_mov_b32 s33, s34
  s_mov_b32 s34, s3
  s_add_u32 s31, s31, 1
  s_cmp_lt_u32 s31, 10
  s_cbranch_scc1 P1_LOOP
  s_branch P1_DONE
P1_WARM:
  s_mov_b64 exec, 0xffffffff
  buffer_load_dword v9, v12, s[8:11], s38 offen
  s_mov_b64 exec, -1
  s_mov_b32 s8, s12
  s_mov_b32 s9, s13
  s_mov_b32 s10, s14
  s_mov_b32 s11, s15
  s_lshr_b32 s40, s24, 1
  s_add_u32 s40, s40, 7
  s_cmp_lt_u32 s31, 7
  s_cselect_b32 s39, s40, 99
  s_branch P1_WARMR
P1_DONE:
  s_waitcnt lgkmcnt(0)
  v_mfma_f32_16x16x32_bf16 v[64:67], v[152:155], v[124:127], v[64:67]
  v_mfma_f32_16x16x32_bf16 v[68:71], v[156:159], v[124:127], v[68:71]
  v_mfma_f32_16x16x32_bf16 v[56:59], v[124:127], v[124:127], v[56:59]
  v_mfma_f32_16x16x32_bf16 v[72:75], v[152:155], v[128:131], v[72:75]
  v_mfma_f32_16x16x32_bf16 v[76:79], v[156:159], v[128:131], v[76:79]
  v_mfma_f32_16x16x32_bf16 v[80:83], v[152:155], v[132:135], v[80:83]
  v_mfma_f32_16x16x32_bf16 v[84:87], v[156:159], v[132:135], v[84:87]
  v_mfma_f32_16x16x32_bf16 v[88:91], v[152:155], v[136:139], v[88:91]
  v_mfma_f32_16x16x32_bf16 v[92:95], v[156:159], v[136:139], v[92:95]
  v_mfma_f32_16x16x32_bf16 v[96:99], v[152:155], v[140:143], v[96:99]
  v_mfma_f32_16x16x32_bf16 v[100:103], v[156:159], v[140:143], v[100:103]
  v_mfma_f32_16x16x32_bf16 v[60:63], v[140:143], v[140:143], v[60:63]
  s_mov_b32 s40, 0x3acccccd
  s_mov_b32 s55, 0x3727c5ac
  s_mov_b64 exec, s[56:57]
  v_cndmask_b32 v56, v56, v57, s[44:45]
  v_cndmask_b32 v58, v58, v59, s[44:45]
  v_cndmask_b32 v56, v56, v58, s[6:7]
  ds_write_b32 v39, v56 offset:4
  s_nop 0
  v_cndmask_b32 v60, v60, v61, s[44:45]
  v_cndmask_b32 v62, v62, v63, s[44:45]
  v_cndmask_b32 v60, v60, v62, s[6:7]
  ds_write_b32 v43, v60 offset:4
  s_cmp_eq_u32 s30, 3
  s_cselect_b64 exec, s[58:59], 0
  s_cbranch_execz P1_NOSUM
  ds_write_b32 v39, v68
  ds_write_b32 v40, v76
  ds_write_b32 v41, v84
  ds_write_b32 v42, v92
  ds_write_b32 v43, v100
P1_NOSUM:
  s_mov_b64 exec, -1
  ds_write_b128 v50, v[96:99]
  ds_write_b128 v50, v[100:103] offset:64
  s_waitcnt lgkmcnt(0)
  s_barrier
  ds_read_b128 v[144:147], v49
  ds_read_b128 v[148:151], v49 offset:64
  ds_read_b64 v[104:105], v39
  ds_read_b64 v[108:109], v40
  ds_read_b64 v[112:113], v41
  ds_read_b64 v[116:117], v42
  ds_read_b64 v[120:121], v43
  s_mov_b32 s64, s40
  s_mov_b32 s67, s55
  s_waitcnt lgkmcnt(4)
  v_mul_f32 v104, s64, v104
  v_mul_f32 v105, s64, v105
  v_fma_f32 v105, -v104, v104, v105
  v_max_f32 v105, 0, v105
  v_add_f32 v105, s67, v105
  v_rsq_f32 v106, v105
  s_waitcnt lgkmcnt(3)
  v_mul_f32 v108, s64, v108
  v_mul_f32 v109, s64, v109
  v_fma_f32 v109, -v108, v108, v109
  v_max_f32 v109, 0, v109
  v_add_f32 v109, s67, v109
  v_rsq_f32 v110, v109
  s_waitcnt lgkmcnt(2)
  v_mul_f32 v112, s64, v112
  v_mul_f32 v113, s64, v113
  v_fma_f32 v113, -v112, v112, v113
  v_max_f32 v113, 0, v113
  v_add_f32 v113, s67, v113
  v_rsq_f32 v114, v113
  s_waitcnt lgkmcnt(1)
  v_mul_f32 v116, s64, v116
  v_mul_f32 v117, s64, v117
  v_fma_f32 v117, -v116, v116, v117
  v_max_f32 v117, 0, v117
  v_add_f32 v117, s67, v117
  v_rsq_f32 v118, v117
  s_waitcnt lgkmcnt(0)
  v_mul_f32 v120, s64, v120
  v_mul_f32 v121, s64, v121
  v_fma_f32 v121, -v120, v120, v121
  v_max_f32 v121, 0, v121
  v_add_f32 v121, s67, v121
  v_rsq_f32 v122, v121
  v_pk_fma_f32 v[64:65], v[144:145], v[104:105], v[64:65] op_sel_hi:[1,0,1] neg_lo:[0,1,0] neg_hi:[0,1,0]
  v_pk_fma_f32 v[66:67], v[146:147], v[104:105], v[66:67] op_sel_hi:[1,0,1] neg_lo:[0,1,0] neg_hi:[0,1,0]
  v_pk_mul_f32 v[64:65], v[64:65], v[106:107] op_sel_hi:[1,0]
  v_pk_mul_f32 v[66:67], v[66:67], v[106:107] op_sel_hi:[1,0]
  v_cvt_pk_bf16_f32 v64, v64, v65
  v_cvt_pk_bf16_f32 v65, v66, v67
  ds_write_b64 v44, v[64:65] offset:0
  v_pk_fma_f32 v[68:69], v[148:149], v[104:105], v[68:69] op_sel_hi:[1,0,1] neg_lo:[0,1,0] neg_hi:[0,1,0]
  v_pk_fma_f32 v[70:71], v[150:151], v[104:105], v[70:71] op_sel_hi:[1,0,1] neg_lo:[0,1,0] neg_hi:[0,1,0]
  v_pk_mul_f32 v[68:69], v[68:69], v[106:107] op_sel_hi:[1,0]
  v_pk_mul_f32 v[70:71], v[70:71], v[106:107] op_sel_hi:[1,0]
  v_cvt_pk_bf16_f32 v68, v68, v69
  v_cvt_pk_bf16_f32 v69, v70, v71
  ds_write_b64 v44, v[68:69] offset:32
  v_pk_fma_f32 v[72:73], v[144:145], v[108:109], v[72:73] op_sel_hi:[1,0,1] neg_lo:[0,1,0] neg_hi:[0,1,0]
  v_pk_fma_f32 v[74:75], v[146:147], v[108:109], v[74:75] op_sel_hi:[1,0,1] neg_lo:[0,1,0] neg_hi:[0,1,0]
  v_pk_mul_f32 v[72:73], v[72:73], v[110:111] op_sel_hi:[1,0]
  v_pk_mul_f32 v[74:75], v[74:75], v[110:111] op_sel_hi:[1,0]
  v_cvt_pk_bf16_f32 v72, v72, v73
  v_cvt_pk_bf16_f32 v73, v74, v75
  ds_write_b64 v45, v[72:73] offset:0
  v_pk_fma_f32 v[76:77], v[148:149], v[108:109], v[76:77] op_sel_hi:[1,0,1] neg_lo:[0,1,0] neg_hi:[0,1,0]
  v_pk_fma_f32 v[78:79], v[150:151], v[108:109], v[78:79] op_sel_hi:[1,0,1] neg_lo:[0,1,0] neg_hi:[0,1,0]
  v_pk_mul_f32 v[76:77], v[76:77], v[110:111] op_sel_hi:[1,0]
  v_pk_mul_f32 v[78:79], v[78:79], v[110:111] op_sel_hi:[1,0]
  v_cvt_pk_bf16_f32 v76, v76, v77
  v_cvt_pk_bf16_f32 v77, v78, v79
  ds_write_b64 v45, v[76:77] offset:32
  v_pk_fma_f32 v[80:81], v[144:145], v[112:113], v[80:81] op_sel_hi:[1,0,1] neg_lo:[0,1,0] neg_hi:[0,1,0]
  v_pk_fma_f32 v[82:83], v[146:147], v[112:113], v[82:83] op_sel_hi:[1,0,1] neg_lo:[0,1,0] neg_hi:[0,1,0]
  v_pk_mul_f32 v[80:81], v[80:81], v[114:115] op_sel_hi:[1,0]
  v_pk_mul_f32 v[82:83], v[82:83], v[114:115] op_sel_hi:[1,0]
  v_cvt_pk_bf16_f32 v80, v80, v81
  v_cvt_pk_bf16_f32 v81, v82, v83
  ds_write_b64 v46, v[80:81] offset:0
  v_pk_fma_f32 v[84:85], v[148:149], v[112:113], v[84:85] op_sel_hi:[1,0,1] neg_lo:[0,1,0] neg_hi:[0,1,0]
  v_pk_fma_f32 v[86:87], v[150:151], v[112:113], v[86:87] op_sel_hi:[1,0,1] neg_lo:[0,1,0] neg_hi:[0,1,0]
  v_pk_mul_f32 v[84:85], v[84:85], v[114:115] op_sel_hi:[1,0]
  v_pk_mul_f32 v[86:87], v[86:87], v[114:115] op_sel_hi:[1,0]
  v_cvt_pk_bf16_f32 v84, v84, v85
  v_cvt_pk_bf16_f32 v85, v86, v87
  ds_write_b64 v46, v[84:85] offset:32
  v_pk_fma_f32 v[88:89], v[144:145], v[116:117], v[88:89] op_sel_hi:[1,0,1] neg_lo:[0,1,0] neg_hi:[0,1,0]
  v_pk_fma_f32 v[90:91], v[146:147], v[116:117], v[90:91] op_sel_hi:[1,0,1] neg_lo:[0,1,0] neg_hi:[0,1,0]
  v_pk_mul_f32 v[88:89], v[88:89], v[118:119] op_sel_hi:[1,0]
  v_pk_mul_f32 v[90:91], v[90:91], v[118:119] op_sel_hi:[1,0]
  v_cvt_pk_bf16_f32 v88, v88, v89
  v_cvt_pk_bf16_f32 v89, v90, v91
  ds_write_b64 v47, v[88:89] offset:0
  v_pk_fma_f32 v[92:93], v[148:149], v[116:117], v[92:93] op_sel_hi:[1,0,1] neg_lo:[0,1,0] neg_hi:[0,1,0]
  v_pk_fma_f32 v[94:95], v[150:151], v[116:117], v[94:95] op_sel_hi:[1,0,1] neg_lo:[0,1,0] neg_hi:[0,1,0]
  v_pk_mul_f32 v[92:93], v[92:93], v[118:119] op_sel_hi:[1,0]
  v_pk_mul_f32 v[94:95], v[94:95], v[118:119] op_sel_hi:[1,0]
  v_cvt_pk_bf16_f32 v92, v92, v93
  v_cvt_pk_bf16_f32 v93, v94, v95
  ds_write_b64 v47, v[92:93] offset:32
  v_pk_fma_f32 v[96:97], v[144:145], v[120:121], v[96:97] op_sel_hi:[1,0,1] neg_lo:[0,1,0] neg_hi:[0,1,0]
  v_pk_fma_f32 v[98:99], v[146:147], v[120:121], v[98:99] op_sel_hi:[1,0,1] neg_lo:[0,1,0] neg_hi:[0,1,0]
  v_pk_mul_f32 v[96:97], v[96:97], v[122:123] op_sel_hi:[1,0]
  v_pk_mul_f32 v[98:99], v[98:99], v[122:123] op_sel_hi:[1,0]
  v_cvt_pk_bf16_f32 v96, v96, v97
  v_cvt_pk_bf16_f32 v97, v98, v99
  ds_write_b64 v48, v[96:97] offset:0
  v_pk_fma_f32 v[100:101], v[148:149], v[120:121], v[100:101] op_sel_hi:[1,0,1] neg_lo:[0,1,0] neg_hi:[0,1,0]
  v_pk_fma_f32 v[102:103], v[150:151], v[120:121], v[102:103] op_sel_hi:[1,0,1] neg_lo:[0,1,0] neg_hi:[0,1,0]
  v_pk_mul_f32 v[100:101], v[100:101], v[122:123] op_sel_hi:[1,0]
  v_pk_mul_f32 v[102:103], v[102:103], v[122:123] op_sel_hi:[1,0]
  v_cvt_pk_bf16_f32 v100, v100, v101
  v_cvt_pk_bf16_f32 v101, v102, v103
  ds_write_b64 v48, v[100:101] offset:32
  s_waitcnt lgkmcnt(0)
  s_barrier
  ds_read_b64 v[68:69], v32 offset:4352
  ds_read_b64 v[70:71], v33 offset:4384
  ds_read_b64 v[72:73], v32 offset:8704
  ds_read_b64 v[74:75], v33 offset:8736
  ds_read_b64 v[56:57], v32 offset:80
  ds_read_b64 v[58:59], v33 offset:112
  ds_read_b64 v[60:61], v32 offset:4432
  ds_read_b64 v[62:63], v33 offset:4464
  ds_read_b64 v[64:65], v32 offset:8784
  ds_read_b64 v[66:67], v33 offset:8816
  s_waitcnt lgkmcnt(8)
  v_cndmask_b32 v70, 0, v70, s[50:51]
  v_cndmask_b32 v71, 0, v71, s[50:51]
  s_waitcnt lgkmcnt(6)
  v_cndmask_b32 v74, 0, v74, s[50:51]
  v_cndmask_b32 v75, 0, v75, s[50:51]
  ds_read_b64_tr_b16 v[76:77], v34 offset:160
  ds_read_b64_tr_b16 v[78:79], v34 offset:4512
  ds_read_b64_tr_b16 v[80:81], v34 offset:192
  ds_read_b64_tr_b16 v[82:83], v34 offset:4544
  ds_read_b64_tr_b16 v[84:85], v34 offset:4512
  ds_read_b64_tr_b16 v[86:87], v34 offset:8864
  ds_read_b64_tr_b16 v[88:89], v34 offset:4544
  ds_read_b64_tr_b16 v[90:91], v34 offset:8896
  s_waitcnt lgkmcnt(12)
  v_mfma_f32_16x16x32_bf16 v[92:95], v[56:59], v[68:71], 0
  s_waitcnt lgkmcnt(10)
  v_mfma_f32_16x16x32_bf16 v[96:99], v[60:63], v[68:71], 0
  v_mfma_f32_16x16x32_bf16 v[100:103], v[60:63], v[72:75], 0
  s_waitcnt lgkmcnt(8)
  v_mfma_f32_16x16x32_bf16 v[104:107], v[64:67], v[72:75], 0
  s_nop 2
  v_cndmask_b32 v132, v92, v93, s[44:45]
  v_cndmask_b32 v133, v94, v95, s[44:45]
  v_cndmask_b32 v134, v96, v97, s[44:45]
  v_cndmask_b32 v135, v98, v99, s[44:45]
  v_cndmask_b32 v132, v38, v132, s[52:53]
  v_cndmask_b32 v133, v38, v133, s[52:53]
  v_cndmask_b32 v132, v132, v134, s[46:47]
  v_cndmask_b32 v133, v133, v135, s[48:49]
  v_max_f32 v136, v132, v133
  v_mov_b32 v137, v136
  v_cndmask_b32 v138, v100, v101, s[44:45]
  v_cndmask_b32 v139, v102, v103, s[44:45]
  v_cndmask_b32 v140, v104, v105, s[44:45]
  v_cndmask_b32 v141, v106, v107, s[44:45]
  v_cndmask_b32 v138, v138, v140, s[46:47]
  v_cndmask_b32 v139, v139, v141, s[48:49]
  v_max_f32 v142, v138, v139
  v_mov_b32 v143, v142
  v_permlane16_swap_b32 v136, v137
  s_nop 0
  v_permlane16_swap_b32 v142, v143
  v_max_f32 v136, v136, v137
  v_mov_b32 v137, v136
  v_max_f32 v142, v142, v143
  v_mov_b32 v143, v142
  v_permlane32_swap_b32 v136, v137
  s_nop 0
  v_permlane32_swap_b32 v142, v143
  v_max_f32 v136, v136, v137
  v_mul_f32 v136, s54, v136
  v_fma_f32 v132, v132, s54, -v136
  v_fma_f32 v133, v133, s54, -v136
  v_exp_f32 v132, v132
  v_exp_f32 v133, v133
  v_max_f32 v142, v142, v143
  v_mul_f32 v142, s54, v142
  v_fma_f32 v138, v138, s54, -v142
  v_fma_f32 v139, v139, s54, -v142
  v_exp_f32 v138, v138
  v_exp_f32 v139, v139
  v_add_f32 v136, v132, v133
  v_mov_b32 v137, v136
  v_add_f32 v142, v138, v139
  v_mov_b32 v143, v142
  v_permlane16_swap_b32 v136, v137
  s_nop 0
  v_permlane16_swap_b32 v142, v143
  v_add_f32 v136, v136, v137
  v_mov_b32 v137, v136
  v_add_f32 v142, v142, v143
  v_mov_b32 v143, v142
  v_permlane32_swap_b32 v136, v137
  s_nop 0
  v_permlane32_swap_b32 v142, v143
  v_add_f32 v136, v136, v137
  v_rcp_f32 v136, v136
  v_add_f32 v142, v142, v143
  v_rcp_f32 v142, v142
  v_mul_f32 v132, v132, v136
  v_mul_f32 v133, v133, v136
  v_cvt_pk_bf16_f32 v132, v132, v132
  v_cvt_pk_bf16_f32 v133, v133, v133
  v_and_b32 v132, v132, v37
  v_and_b32 v133, v133, v37
  v_cndmask_b32 v108, v132, 0, s[46:47]
  v_cndmask_b32 v109, v133, 0, s[48:49]
  v_cndmask_b32 v110, 0, v132, s[46:47]
  v_cndmask_b32 v111, 0, v133, s[48:49]
  v_mul_f32 v138, v138, v142
  v_mul_f32 v139, v139, v142
  v_cvt_pk_bf16_f32 v138, v138, v138
  v_cvt_pk_bf16_f32 v139, v139, v139
  v_and_b32 v138, v138, v37
  v_and_b32 v139, v139, v37
  v_cndmask_b32 v112, v138, 0, s[46:47]
  v_cndmask_b32 v113, v139, 0, s[48:49]
  v_cndmask_b32 v114, 0, v138, s[46:47]
  v_cndmask_b32 v115, 0, v139, s[48:49]
  s_waitcnt lgkmcnt(6)
  v_mfma_f32_16x16x32_bf16 v[116:119], v[76:79], v[108:111], 0
  s_waitcnt lgkmcnt(4)
  v_mfma_f32_16x16x32_bf16 v[120:123], v[80:83], v[108:111], 0
  s_waitcnt lgkmcnt(2)
  v_mfma_f32_16x16x32_bf16 v[124:127], v[84:87], v[112:115], 0
  s_waitcnt lgkmcnt(0)
  v_mfma_f32_16x16x32_bf16 v[128:131], v[88:91], v[112:115], 0
  s_nop 1
  v_cvt_pk_bf16_f32 v116, v116, v117
  v_cvt_pk_bf16_f32 v117, v118, v119
  ds_write_b64 v35, v[116:117] offset:0
  v_cvt_pk_bf16_f32 v120, v120, v121
  v_cvt_pk_bf16_f32 v121, v122, v123
  ds_write_b64 v36, v[120:121] offset:0
  v_cvt_pk_bf16_f32 v124, v124, v125
  v_cvt_pk_bf16_f32 v125, v126, v127
  ds_write_b64 v35, v[124:125] offset:1280
  v_cvt_pk_bf16_f32 v128, v128, v129
  v_cvt_pk_bf16_f32 v129, v130, v131
  ds_write_b64 v36, v[128:129] offset:1280
  s_waitcnt lgkmcnt(0)
  s_barrier
  ds_read_b128 v[116:119], v51
  s_cmp_ge_u32 s24, 2
  s_cbranch_scc1 P1_CO1
  ds_read_b128 v[120:123], v52
  s_waitcnt lgkmcnt(0)
  buffer_store_dwordx4 v[120:123], v54, s[16:19], s35 offen sc1
P1_CO1:
  s_waitcnt lgkmcnt(0)
  buffer_store_dwordx4 v[116:119], v53, s[16:19], s35 offen sc1
  s_waitcnt vmcnt(0)
  s_barrier
  s_and_b32 s56, s24, 3
  s_lshr_b32 s57, s24, 2
  s_add_u32 s16, s92, 8388608
  s_addc_u32 s17, s93, 0
  s_mov_b32 s18, 16384
  s_mov_b32 s19, 0x00020000
  s_add_u32 s20, s92, 3145728
  s_addc_u32 s21, s93, 0
  s_mov_b32 s22, 2621440
  s_mov_b32 s23, 0x00020000
  s_mul_i32 s34, s26, 13
  s_lshr_b32 s34, s34, 6
  s_mul_i32 s33, s34, 5
  s_sub_u32 s33, s26, s33
  s_lshr_b32 s30, s25, 2
  s_mul_i32 s29, s30, 5
  s_add_u32 s33, s33, s29
  s_and_b32 s29, s25, 3
  s_mul_i32 s29, s29, 6
  s_add_u32 s34, s34, s29
  s_lshl_b32 s68, s30, 2
  s_lshr_b32 s29, s26, 3
  s_add_u32 s68, s68, s29
  s_and_b32 s29, s25, 3
  s_lshl_b32 s29, s29, 3
  s_and_b32 s69, s26, 7
  s_add_u32 s69, s69, s29
  v_lshrrev_b32 v6, 3, v1
  s_lshl_b32 s29, s57, 4
  v_add_u32 v6, s29, v6
  v_bfe_u32 v5, v1, 4, 1
  v_lshlrev_b32 v5, 2, v5
  v_and_b32 v7, 7, v1
  v_xor_b32 v5, v5, v7
  v_mul_u32_u24 v7, 3072, v6
  v_lshl_add_u32 v12, v5, 4, v7
  v_add_u32 v13, 23552, v12
  v_bfe_u32 v5, v1, 1, 2
  v_xor_b32 v5, v5, v3
  v_and_b32 v7, 1, v1
  v_lshl_add_u32 v5, v5, 1, v7
  v_lshlrev_b32 v7, 12, v6
  v_lshl_add_u32 v14, v5, 4, v7
  v_add_u32 v15, 31744, v14
  s_mul_i32 s29, s26, 13
  s_lshr_b32 s29, s29, 6
  s_lshl_b32 s29, s29, 2
  s_sub_u32 s7, s26, s29
  s_and_b32 s7, s7, 0
  s_lshr_b32 s29, s26, 3
  s_and_b32 s71, s26, 7
  s_add_u32 s71, s71, s29
  s_sub_u32 s29, s71, 6
  s_cmp_ge_u32 s71, 6
  s_cselect_b32 s71, s29, s71
  s_mov_b32 s71, 0
  s_mov_b32 s4, s7
  s_mov_b32 s5, 8
  s_mov_b32 s6, 1572864
  s_mul_i32 s64, s56, 1572864
  s_mul_i32 s29, s7, 196608
  s_add_u32 s64, s64, s29
  s_lshl_b32 s29, s34, 7
  s_add_u32 s64, s64, s29
  s_mov_b32 s65, 98304
  s_mul_i32 s70, s56, 1572864
  s_mul_i32 s29, s71, 262144
  s_add_u32 s70, s70, s29
  s_lshl_b32 s29, s69, 7
  s_add_u32 s70, s70, s29
  s_mul_i32 s66, s56, 24576
  s_lshl_b32 s29, s57, 11
  s_add_u32 s58, s66, s29
  s_mov_b32 s59, 0
  s_mov_b32 s60, s80
  s_mov_b32 s61, s81
  s_mov_b32 s62, 6291456
  s_mov_b32 s63, 0x00020000
  s_cmp_lt_u32 s2, 240
  s_cbranch_scc1 P2_HASP3A
  s_mov_b32 s60, s84
  s_mov_b32 s61, s85
  s_mov_b32 s64, s70
  s_mov_b32 s65, 131072
  s_mov_b32 s4, s71
  s_mov_b32 s5, 6
  s_mov_b32 s6, 1572864
  v_mov_b32 v12, v14
  v_mov_b32 v13, v15
  s_mov_b32 s59, 16384
P2_HASP3A:
  s_cmp_ge_u32 s24, 4
  s_cbranch_scc1 P2_HELP
  s_lshl_b32 s32, s25, 2
  s_lshr_b32 s29, s26, 3
  s_add_u32 s32, s32, s29
  s_and_b32 s28, s26, 7
  s_lshl_b32 s32, s32, 2
  s_add_u32 s32, s32, s24
  s_mul_i32 s31, s32, 20480
  s_mov_b32 s8, s72
  s_mov_b32 s9, s73
  s_mov_b32 s10, 2621440
  s_mov_b32 s11, 0x00020000
  s_mov_b32 s12, s92
  s_mov_b32 s13, s93
  s_mov_b32 s14, 2621440
  s_mov_b32 s15, 0x00020000
  s_lshl_b32 s29, s32, 4
  v_add_u32 v5, s29, v2
  v_mul_u32_u24 v5, 1280, v5
  v_lshl_add_u32 v5, v3, 4, v5
  s_mul_i32 s30, s28, 160
  v_add_u32 v16, s30, v5
  v_mov_b32 v5, 0x80000000
  v_cmp_gt_u32 vcc, 2, v3
  s_nop 1
  v_cndmask_b32 v17, v5, v16, vcc
  buffer_load_dwordx4 v[84:87], v16, s[8:11], 0 offen
  buffer_load_dwordx4 v[88:91], v16, s[8:11], 0 offen offset:64
  buffer_load_dwordx4 v[92:95], v17, s[8:11], 0 offen offset:128
  v_lshrrev_b32 v5, 3, v2
  v_add_u32 v5, 0, v5
  v_cmp_eq_u32 s[40:41], v5, v3
  v_and_b32 v5, 1, v2
  v_lshlrev_b32 v5, 4, v5
  v_mov_b32 v6, 0x3f80
  v_lshlrev_b32 v6, v5, v6
  v_cndmask_b32 v6, 0, v6, s[40:41]
  v_bfe_u32 v5, v2, 1, 2
  v_cmp_eq_u32 vcc, 0, v5
  s_nop 1
  v_cndmask_b32 v96, 0, v6, vcc
  v_cmp_eq_u32 vcc, 1, v5
  s_nop 1
  v_cndmask_b32 v97, 0, v6, vcc
  v_cmp_eq_u32 vcc, 2, v5
  s_nop 1
  v_cndmask_b32 v98, 0, v6, vcc
  v_cmp_eq_u32 vcc, 3, v5
  s_nop 1
  v_cndmask_b32 v99, 0, v6, vcc
  v_lshrrev_b32 v5, 3, v2
  v_add_u32 v5, 2, v5
  v_cmp_eq_u32 s[40:41], v5, v3
  v_and_b32 v5, 1, v2
  v_lshlrev_b32 v5, 4, v5
  v_mov_b32 v6, 0x3f80
  v_lshlrev_b32 v6, v5, v6
  v_cndmask_b32 v6, 0, v6, s[40:41]
  v_bfe_u32 v5, v2, 1, 2
  v_cmp_eq_u32 vcc, 0, v5
  s_nop 1
  v_cndmask_b32 v100, 0, v6, vcc
  v_cmp_eq_u32 vcc, 1, v5
  s_nop 1
  v_cndmask_b32 v101, 0, v6, vcc
  v_cmp_eq_u32 vcc, 2, v5
  s_nop 1
  v_cndmask_b32 v102, 0, v6, vcc
  v_cmp_eq_u32 vcc, 3, v5
  s_nop 1
  v_cndmask_b32 v103, 0, v6, vcc
  v_bfe_u32 v5, v1, 2, 2
  v_lshl_add_u32 v5, v3, 2, v5
  v_mul_u32_u24 v5, 160, v5
  v_and_b32 v6, 3, v1
  v_lshl_add_u32 v18, v6, 3, v5
  v_add_u32 v18, 46080, v18
  v_add_u32 v19, 51200, v18
  v_lshrrev_b32 v5, 1, v3
  v_lshlrev_b32 v5, 9, v5
  v_lshl_add_u32 v5, v2, 4, v5
  v_and_b32 v6, 1, v3
  v_lshl_add_u32 v16, v6, 3, v5
  v_and_b32 v5, 3, v2
  v_lshl_add_u32 v5, v3, 2, v5
  v_lshlrev_b32 v5, 3, v5
  v_and_b32 v6, 4, v2
  v_add_u32 v5, v5, v6
  v_cmp_ne_u32 s[44:45], 0, v6
  v_mov_b32 v6, 0x80000000
  v_cmp_gt_u32 vcc, 8, v2
  s_nop 1
  v_cndmask_b32 v17, v6, v5, vcc
  v_and_b32 v5, 1, v2
  v_cmp_ne_u32 s[46:47], 0, v5
  v_and_b32 v5, 2, v2
  v_cmp_ne_u32 s[48:49], 0, v5
  s_mul_i32 s30, s28, 5
  s_add_u32 s29, s30, 0
  s_lshr_b32 s55, s29, 1
  s_lshl_b32 s55, s55, 7
  s_add_u32 s55, s55, s32
  s_lshl_b32 s55, s55, 10
  s_and_b32 s29, s29, 1
  s_lshl_b32 s29, s29, 8
  s_add_u32 s50, s55, s29
  s_add_u32 s29, s30, 1
  s_lshr_b32 s55, s29, 1
  s_lshl_b32 s55, s55, 7
  s_add_u32 s55, s55, s32
  s_lshl_b32 s55, s55, 10
  s_and_b32 s29, s29, 1
  s_lshl_b32 s29, s29, 8
  s_add_u32 s51, s55, s29
  s_add_u32 s29, s30, 2
  s_lshr_b32 s55, s29, 1
  s_lshl_b32 s55, s55, 7
  s_add_u32 s55, s55, s32
  s_lshl_b32 s55, s55, 10
  s_and_b32 s29, s29, 1
  s_lshl_b32 s29, s29, 8
  s_add_u32 s52, s55, s29
  s_add_u32 s29, s30, 3
  s_lshr_b32 s55, s29, 1
  s_lshl_b32 s55, s55, 7
  s_add_u32 s55, s55, s32
  s_lshl_b32 s55, s55, 10
  s_and_b32 s29, s29, 1
  s_lshl_b32 s29, s29, 8
  s_add_u32 s53, s55, s29
  s_add_u32 s29, s30, 4
  s_lshr_b32 s55, s29, 1
  s_lshl_b32 s55, s55, 7
  s_add_u32 s55, s55, s32
  s_lshl_b32 s55, s55, 10
  s_and_b32 s29, s29, 1
  s_lshl_b32 s29, s29, 8
  s_add_u32 s54, s55, s29
  s_lshl_b32 s55, s32, 7
  v_lshrrev_b32 v5, 1, v3
  v_lshlrev_b32 v5, 9, v5
  v_lshl_add_u32 v5, v2, 4, v5
  v_and_b32 v6, 1, v3
  s_sub_u32 s29, s51, s50
  v_mul_lo_u32 v7, v6, s29
  v_add_u32 v20, v5, v7
  s_sub_u32 s29, s53, s52
  v_mul_lo_u32 v7, v6, s29
  v_add_u32 v21, v5, v7
  ds_read_b64_tr_b16 v[124:125], v18 offset:0
  ds_read_b64_tr_b16 v[126:127], v18 offset:2560
  ds_read_b64_tr_b16 v[128:129], v18 offset:32
  ds_read_b64_tr_b16 v[130:131], v18 offset:2592
  ds_read_b64_tr_b16 v[132:133], v18 offset:64
  ds_read_b64_tr_b16 v[134:135], v18 offset:2624
  ds_read_b64_tr_b16 v[136:137], v18 offset:96
  ds_read_b64_tr_b16 v[138:139], v18 offset:2656
  ds_read_b64_tr_b16 v[140:141], v18 offset:128
  ds_read_b64_tr_b16 v[142:143], v18 offset:2688
  s_waitcnt vmcnt(0)
  v_mfma_f32_16x16x32_bf16 v[104:107], v[84:87], v[96:99], 0
  v_mfma_f32_16x16x32_bf16 v[108:111], v[84:87], v[100:103], 0
  v_mfma_f32_16x16x32_bf16 v[112:115], v[88:91], v[96:99], 0
  v_mfma_f32_16x16x32_bf16 v[116:119], v[88:91], v[100:103], 0
  v_mfma_f32_16x16x32_bf16 v[120:123], v[92:95], v[96:99], 0
  s_barrier
  buffer_load_dwordx4 v[24:27], v4, s[12:15], s31 offen offset:0 sc1
  buffer_load_dwordx4 v[28:31], v4, s[12:15], s31 offen offset:1024 sc1
  buffer_load_dwordx4 v[32:35], v4, s[12:15], s31 offen offset:2048 sc1
  buffer_load_dwordx4 v[36:39], v4, s[12:15], s31 offen offset:3072 sc1
  s_add_u32 s31, s31, 4096
  buffer_load_dwordx4 v[40:43], v4, s[12:15], s31 offen offset:0 sc1
  buffer_load_dwordx4 v[44:47], v4, s[12:15], s31 offen offset:1024 sc1
  buffer_load_dwordx4 v[48:51], v4, s[12:15], s31 offen offset:2048 sc1
  buffer_load_dwordx4 v[52:55], v4, s[12:15], s31 offen offset:3072 sc1
  s_add_u32 s31, s31, 4096
  buffer_load_dwordx4 v[56:59], v4, s[12:15], s31 offen offset:0 sc1
  buffer_load_dwordx4 v[60:63], v4, s[12:15], s31 offen offset:1024 sc1
  buffer_load_dwordx4 v[64:67], v4, s[12:15], s31 offen offset:2048 sc1
  buffer_load_dwordx4 v[68:71], v4, s[12:15], s31 offen offset:3072 sc1
  s_add_u32 s31, s31, 4096
  buffer_load_dwordx4 v[72:75], v4, s[12:15], s31 offen offset:0 sc1
  buffer_load_dwordx4 v[76:79], v4, s[12:15], s31 offen offset:1024 sc1
  buffer_load_dwordx4 v[80:83], v4, s[12:15], s31 offen offset:2048 sc1
  buffer_load_dwordx4 v[84:87], v4, s[12:15], s31 offen offset:3072 sc1
  s_add_u32 s31, s31, 4096
  buffer_load_dwordx4 v[88:91], v4, s[12:15], s31 offen offset:0 sc1
  buffer_load_dwordx4 v[92:95], v4, s[12:15], s31 offen offset:1024 sc1
  buffer_load_dwordx4 v[96:99], v4, s[12:15], s31 offen offset:2048 sc1
  buffer_load_dwordx4 v[100:103], v4, s[12:15], s31 offen offset:3072 sc1
  ds_read_b64_tr_b16 v[144:145], v18 offset:5120
  ds_read_b64_tr_b16 v[146:147], v18 offset:7680
  ds_read_b64_tr_b16 v[148:149], v18 offset:5152
  ds_read_b64_tr_b16 v[150:151], v18 offset:7712
  ds_read_b64_tr_b16 v[152:153], v18 offset:5184
  s_waitcnt lgkmcnt(14)
  ds_read_b64_tr_b16 v[154:155], v18 offset:7744
  s_waitcnt lgkmcnt(14)
  ds_read_b64_tr_b16 v[156:157], v18 offset:5216
  s_waitcnt lgkmcnt(14)
  ds_read_b64_tr_b16 v[158:159], v18 offset:7776
  s_waitcnt lgkmcnt(14)
  ds_read_b64_tr_b16 v[160:161], v18 offset:5248
  s_waitcnt lgkmcnt(14)
  ds_read_b64_tr_b16 v[162:163], v18 offset:7808
  s_waitcnt vmcnt(19)
  v_mfma_f32_16x16x32_bf16 v[104:107], v[24:27], v[124:127], v[104:107]
  v_mfma_f32_16x16x32_bf16 v[108:111], v[24:27], v[128:131], v[108:111]
  s_waitcnt lgkmcnt(14)
  v_mfma_f32_16x16x32_bf16 v[112:115], v[24:27], v[132:135], v[112:115]
  s_waitcnt lgkmcnt(12)
  v_mfma_f32_16x16x32_bf16 v[116:119], v[24:27], v[136:139], v[116:119]
  s_waitcnt lgkmcnt(10)
  v_mfma_f32_16x16x32_bf16 v[120:123], v[24:27], v[140:143], v[120:123]
  ds_read_b64_tr_b16 v[124:125], v18 offset:10240
  ds_read_b64_tr_b16 v[126:127], v18 offset:12800
  ds_read_b64_tr_b16 v[128:129], v18 offset:10272
  ds_read_b64_tr_b16 v[130:131], v18 offset:12832
  ds_read_b64_tr_b16 v[132:133], v18 offset:10304
  s_waitcnt lgkmcnt(14)
  ds_read_b64_tr_b16 v[134:135], v18 offset:12864
  s_waitcnt lgkmcnt(14)
  ds_read_b64_tr_b16 v[136:137], v18 offset:10336
  s_waitcnt lgkmcnt(14)
  ds_read_b64_tr_b16 v[138:139], v18 offset:12896
  s_waitcnt lgkmcnt(14)
  ds_read_b64_tr_b16 v[140:141], v18 offset:10368
  s_waitcnt lgkmcnt(14)
  ds_read_b64_tr_b16 v[142:143], v18 offset:12928
  s_waitcnt vmcnt(18)
  v_mfma_f32_16x16x32_bf16 v[104:107], v[28:31], v[144:147], v[104:107]
  v_mfma_f32_16x16x32_bf16 v[108:111], v[28:31], v[148:151], v[108:111]
  s_waitcnt lgkmcnt(14)
  v_mfma_f32_16x16x32_bf16 v[112:115], v[28:31], v[152:155], v[112:115]
  s_waitcnt lgkmcnt(12)
  v_mfma_f32_16x16x32_bf16 v[116:119], v[28:31], v[156:159], v[116:119]
  s_waitcnt lgkmcnt(10)
  v_mfma_f32_16x16x32_bf16 v[120:123], v[28:31], v[160:163], v[120:123]
  ds_read_b64_tr_b16 v[144:145], v18 offset:15360
  ds_read_b64_tr_b16 v[146:147], v18 offset:17920
  ds_read_b64_tr_b16 v[148:149], v18 offset:15392
  ds_read_b64_tr_b16 v[150:151], v18 offset:17952
  ds_read_b64_tr_b16 v[152:153], v18 offset:15424
  s_waitcnt lgkmcnt(14)
  ds_read_b64_tr_b16 v[154:155], v18 offset:17984
  s_waitcnt lgkmcnt(14)
  ds_read_b64_tr_b16 v[156:157], v18 offset:15456
  s_waitcnt lgkmcnt(14)
  ds_read_b64_tr_b16 v[158:159], v18 offset:18016
  s_waitcnt lgkmcnt(14)
  ds_read_b64_tr_b16 v[160:161], v18 offset:15488
  s_waitcnt lgkmcnt(14)
  ds_read_b64_tr_b16 v[162:163], v18 offset:18048
  s_waitcnt vmcnt(17)
  v_mfma_f32_16x16x32_bf16 v[104:107], v[32:35], v[124:127], v[104:107]
  v_mfma_f32_16x16x32_bf16 v[108:111], v[32:35], v[128:131], v[108:111]
  s_waitcnt lgkmcnt(14)
  v_mfma_f32_16x16x32_bf16 v[112:115], v[32:35], v[132:135], v[112:115]
  s_waitcnt lgkmcnt(12)
  v_mfma_f32_16x16x32_bf16 v[116:119], v[32:35], v[136:139], v[116:119]
  s_waitcnt lgkmcnt(10)
  v_mfma_f32_16x16x32_bf16 v[120:123], v[32:35], v[140:143], v[120:123]
  ds_read_b64_tr_b16 v[124:125], v18 offset:20480
  ds_read_b64_tr_b16 v[126:127], v18 offset:23040
  ds_read_b64_tr_b16 v[128:129], v18 offset:20512
  ds_read_b64_tr_b16 v[130:131], v18 offset:23072
  ds_read_b64_tr_b16 v[132:133], v18 offset:20544
  s_waitcnt lgkmcnt(14)
  ds_read_b64_tr_b16 v[134:135], v18 offset:23104
  s_waitcnt lgkmcnt(14)
  ds_read_b64_tr_b16 v[136:137], v18 offset:20576
  s_waitcnt lgkmcnt(14)
  ds_read_b64_tr_b16 v[138:139], v18 offset:23136
  s_waitcnt lgkmcnt(14)
  ds_read_b64_tr_b16 v[140:141], v18 offset:20608
  s_waitcnt lgkmcnt(14)
  ds_read_b64_tr_b16 v[142:143], v18 offset:23168
  s_waitcnt vmcnt(16)
  v_mfma_f32_16x16x32_bf16 v[104:107], v[36:39], v[144:147], v[104:107]
  v_mfma_f32_16x16x32_bf16 v[108:111], v[36:39], v[148:151], v[108:111]
  s_waitcnt lgkmcnt(14)
  v_mfma_f32_16x16x32_bf16 v[112:115], v[36:39], v[152:155], v[112:115]
  s_waitcnt lgkmcnt(12)
  v_mfma_f32_16x16x32_bf16 v[116:119], v[36:39], v[156:159], v[116:119]
  s_waitcnt lgkmcnt(10)
  v_mfma_f32_16x16x32_bf16 v[120:123], v[36:39], v[160:163], v[120:123]
  ds_read_b64_tr_b16 v[144:145], v18 offset:25600
  ds_read_b64_tr_b16 v[146:147], v18 offset:28160
  ds_read_b64_tr_b16 v[148:149], v18 offset:25632
  ds_read_b64_tr_b16 v[150:151], v18 offset:28192
  ds_read_b64_tr_b16 v[152:153], v18 offset:25664
  s_waitcnt lgkmcnt(14)
  ds_read_b64_tr_b16 v[154:155], v18 offset:28224
  s_waitcnt lgkmcnt(14)
  ds_read_b64_tr_b16 v[156:157], v18 offset:25696
  s_waitcnt lgkmcnt(14)
  ds_read_b64_tr_b16 v[158:159], v18 offset:28256
  s_waitcnt lgkmcnt(14)
  ds_read_b64_tr_b16 v[160:161], v18 offset:25728
  s_waitcnt lgkmcnt(14)
  ds_read_b64_tr_b16 v[162:163], v18 offset:28288
  s_waitcnt vmcnt(15)
  v_mfma_f32_16x16x32_bf16 v[104:107], v[40:43], v[124:127], v[104:107]
  v_mfma_f32_16x16x32_bf16 v[108:111], v[40:43], v[128:131], v[108:111]
  s_waitcnt lgkmcnt(14)
  v_mfma_f32_16x16x32_bf16 v[112:115], v[40:43], v[132:135], v[112:115]
  s_waitcnt lgkmcnt(12)
  v_mfma_f32_16x16x32_bf16 v[116:119], v[40:43], v[136:139], v[116:119]
  s_waitcnt lgkmcnt(10)
  v_mfma_f32_16x16x32_bf16 v[120:123], v[40:43], v[140:143], v[120:123]
  ds_read_b64_tr_b16 v[124:125], v18 offset:30720
  ds_read_b64_tr_b16 v[126:127], v18 offset:33280
  ds_read_b64_tr_b16 v[128:129], v18 offset:30752
  ds_read_b64_tr_b16 v[130:131], v18 offset:33312
  ds_read_b64_tr_b16 v[132:133], v18 offset:30784
  s_waitcnt lgkmcnt(14)
  ds_read_b64_tr_b16 v[134:135], v18 offset:33344
  s_waitcnt lgkmcnt(14)
  ds_read_b64_tr_b16 v[136:137], v18 offset:30816
  s_waitcnt lgkmcnt(14)
  ds_read_b64_tr_b16 v[138:139], v18 offset:33376
  s_waitcnt lgkmcnt(14)
  ds_read_b64_tr_b16 v[140:141], v18 offset:30848
  s_waitcnt lgkmcnt(14)
  ds_read_b64_tr_b16 v[142:143], v18 offset:33408
  s_waitcnt vmcnt(14)
  v_mfma_f32_16x16x32_bf16 v[104:107], v[44:47], v[144:147], v[104:107]
  v_mfma_f32_16x16x32_bf16 v[108:111], v[44:47], v[148:151], v[108:111]
  s_waitcnt lgkmcnt(14)
  v_mfma_f32_16x16x32_bf16 v[112:115], v[44:47], v[152:155], v[112:115]
  s_waitcnt lgkmcnt(12)
  v_mfma_f32_16x16x32_bf16 v[116:119], v[44:47], v[156:159], v[116:119]
  s_waitcnt lgkmcnt(10)
  v_mfma_f32_16x16x32_bf16 v[120:123], v[44:47], v[160:163], v[120:123]
  ds_read_b64_tr_b16 v[144:145], v18 offset:35840
  ds_read_b64_tr_b16 v[146:147], v18 offset:38400
  ds_read_b64_tr_b16 v[148:149], v18 offset:35872
  ds_read_b64_tr_b16 v[150:151], v18 offset:38432
  ds_read_b64_tr_b16 v[152:153], v18 offset:35904
  s_waitcnt lgkmcnt(14)
  ds_read_b64_tr_b16 v[154:155], v18 offset:38464
  s_waitcnt lgkmcnt(14)
  ds_read_b64_tr_b16 v[156:157], v18 offset:35936
  s_waitcnt lgkmcnt(14)
  ds_read_b64_tr_b16 v[158:159], v18 offset:38496
  s_waitcnt lgkmcnt(14)
  ds_read_b64_tr_b16 v[160:161], v18 offset:35968
  s_waitcnt lgkmcnt(14)
  ds_read_b64_tr_b16 v[162:163], v18 offset:38528
  s_waitcnt vmcnt(13)
  v_mfma_f32_16x16x32_bf16 v[104:107], v[48:51], v[124:127], v[104:107]
  v_mfma_f32_16x16x32_bf16 v[108:111], v[48:51], v[128:131], v[108:111]
  s_waitcnt lgkmcnt(14)
  v_mfma_f32_16x16x32_bf16 v[112:115], v[48:51], v[132:135], v[112:115]
  s_waitcnt lgkmcnt(12)
  v_mfma_f32_16x16x32_bf16 v[116:119], v[48:51], v[136:139], v[116:119]
  s_waitcnt lgkmcnt(10)
  v_mfma_f32_16x16x32_bf16 v[120:123], v[48:51], v[140:143], v[120:123]
  ds_read_b64_tr_b16 v[124:125], v18 offset:40960
  ds_read_b64_tr_b16 v[126:127], v18 offset:43520
  ds_read_b64_tr_b16 v[128:129], v18 offset:40992
  ds_read_b64_tr_b16 v[130:131], v18 offset:43552
  ds_read_b64_tr_b16 v[132:133], v18 offset:41024
  s_waitcnt lgkmcnt(14)
  ds_read_b64_tr_b16 v[134:135], v18 offset:43584
  s_waitcnt lgkmcnt(14)
  ds_read_b64_tr_b16 v[136:137], v18 offset:41056
  s_waitcnt lgkmcnt(14)
  ds_read_b64_tr_b16 v[138:139], v18 offset:43616
  s_waitcnt lgkmcnt(14)
  ds_read_b64_tr_b16 v[140:141], v18 offset:41088
  s_waitcnt lgkmcnt(14)
  ds_read_b64_tr_b16 v[142:143], v18 offset:43648
  s_waitcnt vmcnt(12)
  v_mfma_f32_16x16x32_bf16 v[104:107], v[52:55], v[144:147], v[104:107]
  v_mfma_f32_16x16x32_bf16 v[108:111], v[52:55], v[148:151], v[108:111]
  s_waitcnt lgkmcnt(14)
  v_mfma_f32_16x16x32_bf16 v[112:115], v[52:55], v[152:155], v[112:115]
  s_waitcnt lgkmcnt(12)
  v_mfma_f32_16x16x32_bf16 v[116:119], v[52:55], v[156:159], v[116:119]
  s_waitcnt lgkmcnt(10)
  v_mfma_f32_16x16x32_bf16 v[120:123], v[52:55], v[160:163], v[120:123]
  ds_read_b64_tr_b16 v[144:145], v18 offset:46080
  ds_read_b64_tr_b16 v[146:147], v18 offset:48640
  ds_read_b64_tr_b16 v[148:149], v18 offset:46112
  ds_read_b64_tr_b16 v[150:151], v18 offset:48672
  ds_read_b64_tr_b16 v[152:153], v18 offset:46144
  s_waitcnt lgkmcnt(14)
  ds_read_b64_tr_b16 v[154:155], v18 offset:48704
  s_waitcnt lgkmcnt(14)
  ds_read_b64_tr_b16 v[156:157], v18 offset:46176
  s_waitcnt lgkmcnt(14)
  ds_read_b64_tr_b16 v[158:159], v18 offset:48736
  s_waitcnt lgkmcnt(14)
  ds_read_b64_tr_b16 v[160:161], v18 offset:46208
  s_waitcnt lgkmcnt(14)
  ds_read_b64_tr_b16 v[162:163], v18 offset:48768
  s_waitcnt vmcnt(11)
  v_mfma_f32_16x16x32_bf16 v[104:107], v[56:59], v[124:127], v[104:107]
  v_mfma_f32_16x16x32_bf16 v[108:111], v[56:59], v[128:131], v[108:111]
  s_waitcnt lgkmcnt(14)
  v_mfma_f32_16x16x32_bf16 v[112:115], v[56:59], v[132:135], v[112:115]
  s_waitcnt lgkmcnt(12)
  v_mfma_f32_16x16x32_bf16 v[116:119], v[56:59], v[136:139], v[116:119]
  s_waitcnt lgkmcnt(10)
  v_mfma_f32_16x16x32_bf16 v[120:123], v[56:59], v[140:143], v[120:123]
  ds_read_b64_tr_b16 v[124:125], v19 offset:0
  ds_read_b64_tr_b16 v[126:127], v19 offset:2560
  ds_read_b64_tr_b16 v[128:129], v19 offset:32
  ds_read_b64_tr_b16 v[130:131], v19 offset:2592
  ds_read_b64_tr_b16 v[132:133], v19 offset:64
  s_waitcnt lgkmcnt(14)
  ds_read_b64_tr_b16 v[134:135], v19 offset:2624
  s_waitcnt lgkmcnt(14)
  ds_read_b64_tr_b16 v[136:137], v19 offset:96
  s_waitcnt lgkmcnt(14)
  ds_read_b64_tr_b16 v[138:139], v19 offset:2656
  s_waitcnt lgkmcnt(14)
  ds_read_b64_tr_b16 v[140:141], v19 offset:128
  s_waitcnt lgkmcnt(14)
  ds_read_b64_tr_b16 v[142:143], v19 offset:2688
  s_waitcnt vmcnt(10)
  v_mfma_f32_16x16x32_bf16 v[104:107], v[60:63], v[144:147], v[104:107]
  v_mfma_f32_16x16x32_bf16 v[108:111], v[60:63], v[148:151], v[108:111]
  s_waitcnt lgkmcnt(14)
  v_mfma_f32_16x16x32_bf16 v[112:115], v[60:63], v[152:155], v[112:115]
  s_waitcnt lgkmcnt(12)
  v_mfma_f32_16x16x32_bf16 v[116:119], v[60:63], v[156:159], v[116:119]
  s_waitcnt lgkmcnt(10)
  v_mfma_f32_16x16x32_bf16 v[120:123], v[60:63], v[160:163], v[120:123]
  ds_read_b64_tr_b16 v[144:145], v19 offset:5120
  ds_read_b64_tr_b16 v[146:147], v19 offset:7680
  ds_read_b64_tr_b16 v[148:149], v19 offset:5152
  ds_read_b64_tr_b16 v[150:151], v19 offset:7712
  ds_read_b64_tr_b16 v[152:153], v19 offset:5184
  s_waitcnt lgkmcnt(14)
  ds_read_b64_tr_b16 v[154:155], v19 offset:7744
  s_waitcnt lgkmcnt(14)
  ds_read_b64_tr_b16 v[156:157], v19 offset:5216
  s_waitcnt lgkmcnt(14)
  ds_read_b64_tr_b16 v[158:159], v19 offset:7776
  s_waitcnt lgkmcnt(14)
  ds_read_b64_tr_b16 v[160:161], v19 offset:5248
  s_waitcnt lgkmcnt(14)
  ds_read_b64_tr_b16 v[162:163], v19 offset:7808
  s_waitcnt vmcnt(9)
  v_mfma_f32_16x16x32_bf16 v[104:107], v[64:67], v[124:127], v[104:107]
  v_mfma_f32_16x16x32_bf16 v[108:111], v[64:67], v[128:131], v[108:111]
  s_waitcnt lgkmcnt(14)
  v_mfma_f32_16x16x32_bf16 v[112:115], v[64:67], v[132:135], v[112:115]
  s_waitcnt lgkmcnt(12)
  v_mfma_f32_16x16x32_bf16 v[116:119], v[64:67], v[136:139], v[116:119]
  s_waitcnt lgkmcnt(10)
  v_mfma_f32_16x16x32_bf16 v[120:123], v[64:67], v[140:143], v[120:123]
  ds_read_b64_tr_b16 v[124:125], v19 offset:10240
  ds_read_b64_tr_b16 v[126:127], v19 offset:12800
  ds_read_b64_tr_b16 v[128:129], v19 offset:10272
  ds_read_b64_tr_b16 v[130:131], v19 offset:12832
  ds_read_b64_tr_b16 v[132:133], v19 offset:10304
  s_waitcnt lgkmcnt(14)
  ds_read_b64_tr_b16 v[134:135], v19 offset:12864
  s_waitcnt lgkmcnt(14)
  ds_read_b64_tr_b16 v[136:137], v19 offset:10336
  s_waitcnt lgkmcnt(14)
  ds_read_b64_tr_b16 v[138:139], v19 offset:12896
  s_waitcnt lgkmcnt(14)
  ds_read_b64_tr_b16 v[140:141], v19 offset:10368
  s_waitcnt lgkmcnt(14)
  ds_read_b64_tr_b16 v[142:143], v19 offset:12928
  s_waitcnt vmcnt(8)
  v_mfma_f32_16x16x32_bf16 v[104:107], v[68:71], v[144:147], v[104:107]
  v_mfma_f32_16x16x32_bf16 v[108:111], v[68:71], v[148:151], v[108:111]
  s_waitcnt lgkmcnt(14)
  v_mfma_f32_16x16x32_bf16 v[112:115], v[68:71], v[152:155], v[112:115]
  s_waitcnt lgkmcnt(12)
  v_mfma_f32_16x16x32_bf16 v[116:119], v[68:71], v[156:159], v[116:119]
  s_waitcnt lgkmcnt(10)
  v_mfma_f32_16x16x32_bf16 v[120:123], v[68:71], v[160:163], v[120:123]
  ds_read_b64_tr_b16 v[144:145], v19 offset:15360
  ds_read_b64_tr_b16 v[146:147], v19 offset:17920
  ds_read_b64_tr_b16 v[148:149], v19 offset:15392
  ds_read_b64_tr_b16 v[150:151], v19 offset:17952
  ds_read_b64_tr_b16 v[152:153], v19 offset:15424
  s_waitcnt lgkmcnt(14)
  ds_read_b64_tr_b16 v[154:155], v19 offset:17984
  s_waitcnt lgkmcnt(14)
  ds_read_b64_tr_b16 v[156:157], v19 offset:15456
  s_waitcnt lgkmcnt(14)
  ds_read_b64_tr_b16 v[158:159], v19 offset:18016
  s_waitcnt lgkmcnt(14)
  ds_read_b64_tr_b16 v[160:161], v19 offset:15488
  s_waitcnt lgkmcnt(14)
  ds_read_b64_tr_b16 v[162:163], v19 offset:18048
  s_waitcnt vmcnt(7)
  v_mfma_f32_16x16x32_bf16 v[104:107], v[72:75], v[124:127], v[104:107]
  v_mfma_f32_16x16x32_bf16 v[108:111], v[72:75], v[128:131], v[108:111]
  s_waitcnt lgkmcnt(14)
  v_mfma_f32_16x16x32_bf16 v[112:115], v[72:75], v[132:135], v[112:115]
  s_waitcnt lgkmcnt(12)
  v_mfma_f32_16x16x32_bf16 v[116:119], v[72:75], v[136:139], v[116:119]
  s_waitcnt lgkmcnt(10)
  v_mfma_f32_16x16x32_bf16 v[120:123], v[72:75], v[140:143], v[120:123]
  ds_read_b64_tr_b16 v[124:125], v19 offset:20480
  ds_read_b64_tr_b16 v[126:127], v19 offset:23040
  ds_read_b64_tr_b16 v[128:129], v19 offset:20512
  ds_read_b64_tr_b16 v[130:131], v19 offset:23072
  ds_read_b64_tr_b16 v[132:133], v19 offset:20544
  s_waitcnt lgkmcnt(14)
  ds_read_b64_tr_b16 v[134:135], v19 offset:23104
  s_waitcnt lgkmcnt(14)
  ds_read_b64_tr_b16 v[136:137], v19 offset:20576
  s_waitcnt lgkmcnt(14)
  ds_read_b64_tr_b16 v[138:139], v19 offset:23136
  s_waitcnt lgkmcnt(14)
  ds_read_b64_tr_b16 v[140:141], v19 offset:20608
  s_waitcnt lgkmcnt(14)
  ds_read_b64_tr_b16 v[142:143], v19 offset:23168
  s_waitcnt vmcnt(6)
  v_mfma_f32_16x16x32_bf16 v[104:107], v[76:79], v[144:147], v[104:107]
  v_mfma_f32_16x16x32_bf16 v[108:111], v[76:79], v[148:151], v[108:111]
  s_waitcnt lgkmcnt(14)
  v_mfma_f32_16x16x32_bf16 v[112:115], v[76:79], v[152:155], v[112:115]
  s_waitcnt lgkmcnt(12)
  v_mfma_f32_16x16x32_bf16 v[116:119], v[76:79], v[156:159], v[116:119]
  s_waitcnt lgkmcnt(10)
  v_mfma_f32_16x16x32_bf16 v[120:123], v[76:79], v[160:163], v[120:123]
  ds_read_b64_tr_b16 v[144:145], v19 offset:25600
  ds_read_b64_tr_b16 v[146:147], v19 offset:28160
  ds_read_b64_tr_b16 v[148:149], v19 offset:25632
  ds_read_b64_tr_b16 v[150:151], v19 offset:28192
  ds_read_b64_tr_b16 v[152:153], v19 offset:25664
  s_waitcnt lgkmcnt(14)
  ds_read_b64_tr_b16 v[154:155], v19 offset:28224
  s_waitcnt lgkmcnt(14)
  ds_read_b64_tr_b16 v[156:157], v19 offset:25696
  s_waitcnt lgkmcnt(14)
  ds_read_b64_tr_b16 v[158:159], v19 offset:28256
  s_waitcnt lgkmcnt(14)
  ds_read_b64_tr_b16 v[160:161], v19 offset:25728
  s_waitcnt lgkmcnt(14)
  ds_read_b64_tr_b16 v[162:163], v19 offset:28288
  s_waitcnt vmcnt(5)
  v_mfma_f32_16x16x32_bf16 v[104:107], v[80:83], v[124:127], v[104:107]
  v_mfma_f32_16x16x32_bf16 v[108:111], v[80:83], v[128:131], v[108:111]
  s_waitcnt lgkmcnt(14)
  v_mfma_f32_16x16x32_bf16 v[112:115], v[80:83], v[132:135], v[112:115]
  s_waitcnt lgkmcnt(12)
  v_mfma_f32_16x16x32_bf16 v[116:119], v[80:83], v[136:139], v[116:119]
  s_waitcnt lgkmcnt(10)
  v_mfma_f32_16x16x32_bf16 v[120:123], v[80:83], v[140:143], v[120:123]
  ds_read_b64_tr_b16 v[124:125], v19 offset:30720
  ds_read_b64_tr_b16 v[126:127], v19 offset:33280
  ds_read_b64_tr_b16 v[128:129], v19 offset:30752
  ds_read_b64_tr_b16 v[130:131], v19 offset:33312
  ds_read_b64_tr_b16 v[132:133], v19 offset:30784
  s_waitcnt lgkmcnt(14)
  ds_read_b64_tr_b16 v[134:135], v19 offset:33344
  s_waitcnt lgkmcnt(14)
  ds_read_b64_tr_b16 v[136:137], v19 offset:30816
  s_waitcnt lgkmcnt(14)
  ds_read_b64_tr_b16 v[138:139], v19 offset:33376
  s_waitcnt lgkmcnt(14)
  ds_read_b64_tr_b16 v[140:141], v19 offset:30848
  s_waitcnt lgkmcnt(14)
  ds_read_b64_tr_b16 v[142:143], v19 offset:33408
  s_waitcnt vmcnt(4)
  v_mfma_f32_16x16x32_bf16 v[104:107], v[84:87], v[144:147], v[104:107]
  v_mfma_f32_16x16x32_bf16 v[108:111], v[84:87], v[148:151], v[108:111]
  s_waitcnt lgkmcnt(14)
  v_mfma_f32_16x16x32_bf16 v[112:115], v[84:87], v[152:155], v[112:115]
  s_waitcnt lgkmcnt(12)
  v_mfma_f32_16x16x32_bf16 v[116:119], v[84:87], v[156:159], v[116:119]
  s_waitcnt lgkmcnt(10)
  v_mfma_f32_16x16x32_bf16 v[120:123], v[84:87], v[160:163], v[120:123]
  ds_read_b64_tr_b16 v[144:145], v19 offset:35840
  ds_read_b64_tr_b16 v[146:147], v19 offset:38400
  ds_read_b64_tr_b16 v[148:149], v19 offset:35872
  ds_read_b64_tr_b16 v[150:151], v19 offset:38432
  ds_read_b64_tr_b16 v[152:153], v19 offset:35904
  s_waitcnt lgkmcnt(14)
  ds_read_b64_tr_b16 v[154:155], v19 offset:38464
  s_waitcnt lgkmcnt(14)
  ds_read_b64_tr_b16 v[156:157], v19 offset:35936
  s_waitcnt lgkmcnt(14)
  ds_read_b64_tr_b16 v[158:159], v19 offset:38496
  s_waitcnt lgkmcnt(14)
  ds_read_b64_tr_b16 v[160:161], v19 offset:35968
  s_waitcnt lgkmcnt(14)
  ds_read_b64_tr_b16 v[162:163], v19 offset:38528
  s_waitcnt vmcnt(3)
  v_mfma_f32_16x16x32_bf16 v[104:107], v[88:91], v[124:127], v[104:107]
  v_mfma_f32_16x16x32_bf16 v[108:111], v[88:91], v[128:131], v[108:111]
  s_waitcnt lgkmcnt(14)
  v_mfma_f32_16x16x32_bf16 v[112:115], v[88:91], v[132:135], v[112:115]
  s_waitcnt lgkmcnt(12)
  v_mfma_f32_16x16x32_bf16 v[116:119], v[88:91], v[136:139], v[116:119]
  s_waitcnt lgkmcnt(10)
  v_mfma_f32_16x16x32_bf16 v[120:123], v[88:91], v[140:143], v[120:123]
  ds_read_b64_tr_b16 v[124:125], v19 offset:40960
  ds_read_b64_tr_b16 v[126:127], v19 offset:43520
  ds_read_b64_tr_b16 v[128:129], v19 offset:40992
  ds_read_b64_tr_b16 v[130:131], v19 offset:43552
  ds_read_b64_tr_b16 v[132:133], v19 offset:41024
  s_waitcnt lgkmcnt(14)
  ds_read_b64_tr_b16 v[134:135], v19 offset:43584
  s_waitcnt lgkmcnt(14)
  ds_read_b64_tr_b16 v[136:137], v19 offset:41056
  s_waitcnt lgkmcnt(14)
  ds_read_b64_tr_b16 v[138:139], v19 offset:43616
  s_waitcnt lgkmcnt(14)
  ds_read_b64_tr_b16 v[140:141], v19 offset:41088
  s_waitcnt lgkmcnt(14)
  ds_read_b64_tr_b16 v[142:143], v19 offset:43648
  s_waitcnt vmcnt(2)
  v_mfma_f32_16x16x32_bf16 v[104:107], v[92:95], v[144:147], v[104:107]
  v_mfma_f32_16x16x32_bf16 v[108:111], v[92:95], v[148:151], v[108:111]
  s_waitcnt lgkmcnt(14)
  v_mfma_f32_16x16x32_bf16 v[112:115], v[92:95], v[152:155], v[112:115]
  s_waitcnt lgkmcnt(12)
  v_mfma_f32_16x16x32_bf16 v[116:119], v[92:95], v[156:159], v[116:119]
  s_waitcnt lgkmcnt(10)
  v_mfma_f32_16x16x32_bf16 v[120:123], v[92:95], v[160:163], v[120:123]
  ds_read_b64_tr_b16 v[144:145], v19 offset:46080
  ds_read_b64_tr_b16 v[146:147], v19 offset:48640
  ds_read_b64_tr_b16 v[148:149], v19 offset:46112
  ds_read_b64_tr_b16 v[150:151], v19 offset:48672
  ds_read_b64_tr_b16 v[152:153], v19 offset:46144
  s_waitcnt lgkmcnt(14)
  ds_read_b64_tr_b16 v[154:155], v19 offset:48704
  s_waitcnt lgkmcnt(14)
  ds_read_b64_tr_b16 v[156:157], v19 offset:46176
  s_waitcnt lgkmcnt(14)
  ds_read_b64_tr_b16 v[158:159], v19 offset:48736
  s_waitcnt lgkmcnt(14)
  ds_read_b64_tr_b16 v[160:161], v19 offset:46208
  s_waitcnt lgkmcnt(14)
  ds_read_b64_tr_b16 v[162:163], v19 offset:48768
  s_waitcnt vmcnt(1)
  v_mfma_f32_16x16x32_bf16 v[104:107], v[96:99], v[124:127], v[104:107]
  v_mfma_f32_16x16x32_bf16 v[108:111], v[96:99], v[128:131], v[108:111]
  s_waitcnt lgkmcnt(14)
  v_mfma_f32_16x16x32_bf16 v[112:115], v[96:99], v[132:135], v[112:115]
  s_waitcnt lgkmcnt(12)
  v_mfma_f32_16x16x32_bf16 v[116:119], v[96:99], v[136:139], v[116:119]
  s_waitcnt lgkmcnt(10)
  v_mfma_f32_16x16x32_bf16 v[120:123], v[96:99], v[140:143], v[120:123]
  s_waitcnt vmcnt(0)
  s_waitcnt lgkmcnt(8)
  v_mfma_f32_16x16x32_bf16 v[104:107], v[100:103], v[144:147], v[104:107]
  s_waitcnt lgkmcnt(6)
  v_mfma_f32_16x16x32_bf16 v[108:111], v[100:103], v[148:151], v[108:111]
  s_waitcnt lgkmcnt(4)
  v_mfma_f32_16x16x32_bf16 v[112:115], v[100:103], v[152:155], v[112:115]
  s_waitcnt lgkmcnt(2)
  v_mfma_f32_16x16x32_bf16 v[116:119], v[100:103], v[156:159], v[116:119]
  s_waitcnt lgkmcnt(0)
  v_mfma_f32_16x16x32_bf16 v[120:123], v[100:103], v[160:163], v[120:123]
  s_barrier
  v_cvt_pk_bf16_f32 v56, v104, v105
  v_cvt_pk_bf16_f32 v57, v106, v107
  v_lshlrev_b32 v32, 16, v56
  v_and_b32 v33, 0xffff0000, v56
  v_lshlrev_b32 v34, 16, v57
  v_and_b32 v35, 0xffff0000, v57
  v_pk_mul_f32 v[28:29], v[32:33], v[32:33]
  v_pk_mul_f32 v[30:31], v[34:35], v[34:35]
  v_cvt_pk_bf16_f32 v58, v108, v109
  v_cvt_pk_bf16_f32 v59, v110, v111
  v_lshlrev_b32 v36, 16, v58
  v_and_b32 v37, 0xffff0000, v58
  v_lshlrev_b32 v38, 16, v59
  v_and_b32 v39, 0xffff0000, v59
  v_permlane16_swap_b32 v56, v58
  v_permlane16_swap_b32 v57, v59
  buffer_store_dwordx4 v[56:59], v20, s[20:23], s50 offen sc1
  v_pk_add_f32 v[24:25], v[32:33], v[36:37]
  v_pk_fma_f32 v[28:29], v[36:37], v[36:37], v[28:29]
  v_pk_add_f32 v[26:27], v[34:35], v[38:39]
  v_pk_fma_f32 v[30:31], v[38:39], v[38:39], v[30:31]
  v_cvt_pk_bf16_f32 v60, v112, v113
  v_cvt_pk_bf16_f32 v61, v114, v115
  v_lshlrev_b32 v40, 16, v60
  v_and_b32 v41, 0xffff0000, v60
  v_lshlrev_b32 v42, 16, v61
  v_and_b32 v43, 0xffff0000, v61
  v_pk_add_f32 v[24:25], v[24:25], v[40:41]
  v_pk_fma_f32 v[28:29], v[40:41], v[40:41], v[28:29]
  v_pk_add_f32 v[26:27], v[26:27], v[42:43]
  v_pk_fma_f32 v[30:31], v[42:43], v[42:43], v[30:31]
  v_cvt_pk_bf16_f32 v62, v116, v117
  v_cvt_pk_bf16_f32 v63, v118, v119
  v_lshlrev_b32 v44, 16, v62
  v_and_b32 v45, 0xffff0000, v62
  v_lshlrev_b32 v46, 16, v63
  v_and_b32 v47, 0xffff0000, v63
  v_permlane16_swap_b32 v60, v62
  v_permlane16_swap_b32 v61, v63
  buffer_store_dwordx4 v[60:63], v21, s[20:23], s52 offen sc1
  v_pk_add_f32 v[24:25], v[24:25], v[44:45]
  v_pk_fma_f32 v[28:29], v[44:45], v[44:45], v[28:29]
  v_pk_add_f32 v[26:27], v[26:27], v[46:47]
  v_pk_fma_f32 v[30:31], v[46:47], v[46:47], v[30:31]
  v_cvt_pk_bf16_f32 v64, v120, v121
  v_cvt_pk_bf16_f32 v65, v122, v123
  v_lshlrev_b32 v48, 16, v64
  v_and_b32 v49, 0xffff0000, v64
  v_lshlrev_b32 v50, 16, v65
  v_and_b32 v51, 0xffff0000, v65
  buffer_store_dwordx2 v[64:65], v16, s[20:23], s54 offen sc1
  v_pk_add_f32 v[24:25], v[24:25], v[48:49]
  v_pk_fma_f32 v[28:29], v[48:49], v[48:49], v[28:29]
  v_pk_add_f32 v[26:27], v[26:27], v[50:51]
  v_pk_fma_f32 v[30:31], v[50:51], v[50:51], v[30:31]
  v_add_f32_dpp v24, v24, v24 row_ror:8 row_mask:0xf bank_mask:0xf
  v_add_f32_dpp v25, v25, v25 row_ror:8 row_mask:0xf bank_mask:0xf
  v_add_f32_dpp v26, v26, v26 row_ror:8 row_mask:0xf bank_mask:0xf
  v_add_f32_dpp v27, v27, v27 row_ror:8 row_mask:0xf bank_mask:0xf
  v_add_f32_dpp v28, v28, v28 row_ror:8 row_mask:0xf bank_mask:0xf
  v_add_f32_dpp v29, v29, v29 row_ror:8 row_mask:0xf bank_mask:0xf
  v_add_f32_dpp v30, v30, v30 row_ror:8 row_mask:0xf bank_mask:0xf
  v_add_f32_dpp v31, v31, v31 row_ror:8 row_mask:0xf bank_mask:0xf
  v_add_f32_dpp v24, v24, v24 row_ror:4 row_mask:0xf bank_mask:0xf
  v_add_f32_dpp v25, v25, v25 row_ror:4 row_mask:0xf bank_mask:0xf
  v_add_f32_dpp v26, v26, v26 row_ror:4 row_mask:0xf bank_mask:0xf
  v_add_f32_dpp v27, v27, v27 row_ror:4 row_mask:0xf bank_mask:0xf
  v_add_f32_dpp v28, v28, v28 row_ror:4 row_mask:0xf bank_mask:0xf
  v_add_f32_dpp v29, v29, v29 row_ror:4 row_mask:0xf bank_mask:0xf
  v_add_f32_dpp v30, v30, v30 row_ror:4 row_mask:0xf bank_mask:0xf
  v_add_f32_dpp v31, v31, v31 row_ror:4 row_mask:0xf bank_mask:0xf
  v_add_f32_dpp v24, v24, v24 row_ror:2 row_mask:0xf bank_mask:0xf
  v_add_f32_dpp v25, v25, v25 row_ror:2 row_mask:0xf bank_mask:0xf
  v_add_f32_dpp v26, v26, v26 row_ror:2 row_mask:0xf bank_mask:0xf
  v_add_f32_dpp v27, v27, v27 row_ror:2 row_mask:0xf bank_mask:0xf
  v_add_f32_dpp v28, v28, v28 row_ror:2 row_mask:0xf bank_mask:0xf
  v_add_f32_dpp v29, v29, v29 row_ror:2 row_mask:0xf bank_mask:0xf
  v_add_f32_dpp v30, v30, v30 row_ror:2 row_mask:0xf bank_mask:0xf
  v_add_f32_dpp v31, v31, v31 row_ror:2 row_mask:0xf bank_mask:0xf
  v_add_f32_dpp v24, v24, v24 row_ror:1 row_mask:0xf bank_mask:0xf
  v_add_f32_dpp v25, v25, v25 row_ror:1 row_mask:0xf bank_mask:0xf
  v_add_f32_dpp v26, v26, v26 row_ror:1 row_mask:0xf bank_mask:0xf
  v_add_f32_dpp v27, v27, v27 row_ror:1 row_mask:0xf bank_mask:0xf
  v_add_f32_dpp v28, v28, v28 row_ror:1 row_mask:0xf bank_mask:0xf
  v_add_f32_dpp v29, v29, v29 row_ror:1 row_mask:0xf bank_mask:0xf
  v_add_f32_dpp v30, v30, v30 row_ror:1 row_mask:0xf bank_mask:0xf
  v_add_f32_dpp v31, v31, v31 row_ror:1 row_mask:0xf bank_mask:0xf
  v_cndmask_b32 v24, v24, v28, s[44:45]
  v_cndmask_b32 v25, v25, v29, s[44:45]
  v_cndmask_b32 v26, v26, v30, s[44:45]
  v_cndmask_b32 v27, v27, v31, s[44:45]
  v_cndmask_b32 v24, v24, v25, s[46:47]
  v_cndmask_b32 v26, v26, v27, s[46:47]
  v_cndmask_b32 v24, v24, v26, s[48:49]
  buffer_atomic_add_f32 v24, v17, s[16:19], s55 offen
  s_waitcnt vmcnt(0)
  s_barrier
  s_branch P2_JOIN
P2_HELP:
  s_barrier
  s_barrier
  s_barrier
P2_JOIN:
  s_mov_b32 s67, 0
  s_cmp_ge_u32 s2, 240
  s_cbranch_scc1 P3_SKIP
  v_lshrrev_b32 v16, 5, v1
  s_lshl_b32 s28, s33, 1
  s_add_u32 s28, s28, s57
  s_lshl_b32 s28, s28, 7
  s_lshl_b32 s29, s56, 5
  s_add_u32 s28, s28, s29
  s_lshl_b32 s28, s28, 10
  s_lshl_b32 s29, s7, 12
  s_add_u32 s28, s28, s29
  s_mov_b32 s100, s7
  s_mov_b32 s8, s82
  s_mov_b32 s9, s83
  s_mov_b32 s10, 3072
  s_mov_b32 s11, 0x00020000
  s_add_u32 s12, s92, 6291456
  s_addc_u32 s13, s93, 0
  s_mov_b32 s14, 1966080
  s_mov_b32 s15, 0x00020000
  v_bfe_u32 v5, v1, 2, 2
  v_lshl_add_u32 v6, v16, 3, v5
  v_lshlrev_b32 v6, 7, v6
  v_bfe_u32 v5, v1, 3, 1
  v_lshlrev_b32 v5, 2, v5
  v_bfe_u32 v7, v1, 4, 1
  v_lshl_or_b32 v5, v7, 1, v5
  v_bfe_u32 v7, v1, 1, 1
  v_or_b32 v5, v5, v7
  v_lshl_add_u32 v6, v5, 4, v6
  v_and_b32 v7, 1, v1
  v_lshl_add_u32 v6, v7, 3, v6
  v_add_u32 v17, s66, v6
  v_xor_b32 v6, 64, v6
  v_add_u32 v18, s66, v6
  s_lshl_b32 s29, s56, 12
  s_add_u32 s29, s29, 98304
  v_lshlrev_b32 v5, 6, v16
  v_add_u32 v22, s29, v5
  s_lshl_b32 s30, s57, 11
  s_add_u32 s29, s29, s30
  v_lshrrev_b32 v5, 1, v1
  v_lshlrev_b32 v5, 6, v5
  v_and_b32 v6, 1, v1
  v_lshl_add_u32 v5, v6, 4, v5
  v_add_u32 v8, s29, v5
  v_lshlrev_b32 v7, 5, v1
  s_and_b32 s29, s24, 3
  s_lshl_b32 s29, s29, 5
  s_lshl_b32 s30, s34, 7
  s_add_u32 s32, s29, s30
  v_lshlrev_b32 v5, 3, v16
  buffer_load_dwordx2 v[24:25], v5, s[8:11], s32 offen offset:0
  buffer_load_dwordx2 v[26:27], v5, s[8:11], s32 offen offset:16
  v_mov_b32 v60, 0
  v_mov_b32 v61, 0
  v_mov_b32 v62, 0
  v_mov_b32 v63, 0
  v_mov_b32 v64, 0
  v_mov_b32 v65, 0
  v_mov_b32 v66, 0
  v_mov_b32 v67, 0
  v_mov_b32 v68, 0
  v_mov_b32 v69, 0
  v_mov_b32 v70, 0
  v_mov_b32 v71, 0
  v_mov_b32 v72, 0
  v_mov_b32 v73, 0
  v_mov_b32 v74, 0
  v_mov_b32 v75, 0
  v_mov_b32 v76, 0
  v_mov_b32 v77, 0
  v_mov_b32 v78, 0
  v_mov_b32 v79, 0
  v_mov_b32 v80, 0
  v_mov_b32 v81, 0
  v_mov_b32 v82, 0
  v_mov_b32 v83, 0
  v_mov_b32 v84, 0
  v_mov_b32 v85, 0
  v_mov_b32 v86, 0
  v_mov_b32 v87, 0
  v_mov_b32 v88, 0
  v_mov_b32 v89, 0
  v_mov_b32 v90, 0
  v_mov_b32 v91, 0
  s_lshl_b32 s32, s56, 12
  s_lshl_b32 s30, s57, 11
  s_add_u32 s32, s32, s30
  s_mov_b32 s29, 0x3acccccd
  s_mov_b32 s30, 0x3727c5ac
  s_mov_b32 s35, 0x80000000
  s_mov_b32 s27, 0
  s_barrier
  buffer_load_dwordx4 v[148:151], v7, s[16:19], s32 offen offset:0 sc1
  buffer_load_dwordx4 v[152:155], v7, s[16:19], s32 offen offset:16 sc1
  buffer_load_dwordx4 v[28:31], v4, s[20:23], s28 offen sc1
  buffer_load_dwordx4 v[32:35], v4, s[20:23], s28 offen offset:1024 sc1
  s_add_u32 s28, s28, 2048
  buffer_load_dwordx4 v[36:39], v4, s[20:23], s28 offen sc1
  buffer_load_dwordx4 v[40:43], v4, s[20:23], s28 offen offset:1024 sc1
  s_add_u32 s28, s28, 2048
  s_add_u32 s100, s100, 1
  s_cmp_eq_u32 s100, 8
  s_cselect_b32 s101, 32768, 0
  s_cselect_b32 s100, 0, s100
  s_sub_u32 s28, s28, s101
  buffer_load_dwordx4 v[44:47], v4, s[20:23], s28 offen sc1
  buffer_load_dwordx4 v[48:51], v4, s[20:23], s28 offen offset:1024 sc1
  s_add_u32 s28, s28, 2048
  buffer_load_dwordx4 v[52:55], v4, s[20:23], s28 offen sc1
  buffer_load_dwordx4 v[56:59], v4, s[20:23], s28 offen offset:1024 sc1
  s_add_u32 s28, s28, 2048
  s_add_u32 s100, s100, 1
  s_cmp_eq_u32 s100, 8
  s_cselect_b32 s101, 32768, 0
  s_cselect_b32 s100, 0, s100
  s_sub_u32 s28, s28, s101
  s_waitcnt vmcnt(8)
  v_mul_f32 v148, s29, v148
  v_mul_f32 v149, s29, v149
  v_fma_f32 v149, -v148, v148, v149
  v_max_f32 v149, 0, v149
  v_add_f32 v108, s30, v149
  v_rsq_f32 v108, v108
  v_mul_f32 v150, s29, v150
  v_mul_f32 v151, s29, v151
  v_fma_f32 v151, -v150, v150, v151
  v_max_f32 v151, 0, v151
  v_add_f32 v109, s30, v151
  v_rsq_f32 v109, v109
  v_mul_f32 v152, s29, v152
  v_mul_f32 v153, s29, v153
  v_fma_f32 v153, -v152, v152, v153
  v_max_f32 v153, 0, v153
  v_add_f32 v110, s30, v153
  v_rsq_f32 v110, v110
  v_mul_f32 v154, s29, v154
  v_mul_f32 v155, s29, v155
  v_fma_f32 v155, -v154, v154, v155
  v_max_f32 v155, 0, v155
  v_add_f32 v111, s30, v155
  v_rsq_f32 v111, v111
  v_mul_f32 v149, v149, v108
  v_fma_f32 v149, v149, v108, s30
  v_rsq_f32 v149, v149
  v_mul_f32 v151, v151, v109
  v_fma_f32 v151, v151, v109, s30
  v_rsq_f32 v151, v151
  v_mul_f32 v153, v153, v110
  v_fma_f32 v153, v153, v110, s30
  v_rsq_f32 v153, v153
  v_mul_f32 v155, v155, v111
  v_fma_f32 v155, v155, v111, s30
  v_rsq_f32 v155, v155
  v_mul_f32 v108, v149, v108
  v_mul_f32 v112, -v148, v108
  v_mul_f32 v109, v151, v109
  v_mul_f32 v113, -v150, v109
  v_mul_f32 v110, v153, v110
  v_mul_f32 v114, -v152, v110
  v_mul_f32 v111, v155, v111
  v_mul_f32 v115, -v154, v111
  ds_write_b128 v8, v[108:111]
  ds_write_b128 v8, v[112:115] offset:32
  s_mov_b32 s48, s64
  s_mov_b32 s49, s4
P3_LOOP:
  s_waitcnt vmcnt(4)
  s_waitcnt lgkmcnt(0)
  s_barrier
  s_add_u32 s29, s27, s7
  s_and_b32 s29, s29, 7
  s_lshl_b32 s29, s29, 9
  v_add_u32 v21, s29, v22
  v_add_u32 v19, s67, v17
  v_add_u32 v20, s67, v18
  ds_read_b128 v[108:111], v21 offset:0
  ds_read_b128 v[112:115], v21 offset:16
  ds_read_b128 v[116:119], v21 offset:32
  ds_read_b128 v[120:123], v21 offset:48
  ds_read_b64_tr_b16 v[92:93], v19 offset:0
  ds_read_b64_tr_b16 v[94:95], v19 offset:512
  ds_read_b64_tr_b16 v[96:97], v20 offset:0
  ds_read_b64_tr_b16 v[98:99], v20 offset:512
  ds_read_b128 v[124:127], v21 offset:128
  ds_read_b128 v[128:131], v21 offset:144
  ds_read_b128 v[132:135], v21 offset:160
  ds_read_b128 v[136:139], v21 offset:176
  ds_read_b64_tr_b16 v[100:101], v19 offset:2048
  ds_read_b64_tr_b16 v[102:103], v19 offset:2560
  ds_read_b64_tr_b16 v[104:105], v20 offset:2048
  s_waitcnt lgkmcnt(14)
  ds_read_b64_tr_b16 v[106:107], v20 offset:2560
  v_lshlrev_b32 v148, 16, v28
  v_and_b32 v149, 0xffff0000, v28
  v_lshlrev_b32 v150, 16, v29
  v_and_b32 v151, 0xffff0000, v29
  v_lshlrev_b32 v152, 16, v30
  v_and_b32 v153, 0xffff0000, v30
  v_lshlrev_b32 v154, 16, v31
  v_and_b32 v155, 0xffff0000, v31
  v_lshlrev_b32 v156, 16, v32
  v_and_b32 v157, 0xffff0000, v32
  v_lshlrev_b32 v158, 16, v33
  v_and_b32 v159, 0xffff0000, v33
  v_lshlrev_b32 v160, 16, v34
  v_and_b32 v161, 0xffff0000, v34
  v_lshlrev_b32 v162, 16, v35
  v_and_b32 v163, 0xffff0000, v35
  s_cmp_ge_u32 s27, 6
  s_cbranch_scc1 P3_NH00
  buffer_load_dwordx4 v[28:31], v4, s[20:23], s28 offen sc1
  buffer_load_dwordx4 v[32:35], v4, s[20:23], s28 offen offset:1024 sc1
  s_add_u32 s28, s28, 2048
P3_NH00:
  s_waitcnt lgkmcnt(13)
  v_pk_fma_f32 v[148:149], v[148:149], v[108:109], v[116:117]
  v_pk_fma_f32 v[150:151], v[150:151], v[110:111], v[118:119]
  s_waitcnt lgkmcnt(12)
  v_pk_fma_f32 v[152:153], v[152:153], v[112:113], v[120:121]
  v_pk_fma_f32 v[154:155], v[154:155], v[114:115], v[122:123]
  v_cvt_pk_bf16_f32 v140, v148, v149
  v_cvt_pk_bf16_f32 v141, v150, v151
  v_cvt_pk_bf16_f32 v142, v152, v153
  v_cvt_pk_bf16_f32 v143, v154, v155
  s_waitcnt lgkmcnt(10)
  s_nop 0
  v_mfma_f32_32x32x16_bf16 v[60:75], v[92:95], v[140:143], v[60:75]
  s_waitcnt lgkmcnt(8)
  v_mfma_f32_32x32x16_bf16 v[76:91], v[96:99], v[140:143], v[76:91]
  s_waitcnt lgkmcnt(5)
  v_pk_fma_f32 v[156:157], v[156:157], v[124:125], v[132:133]
  v_pk_fma_f32 v[158:159], v[158:159], v[126:127], v[134:135]
  s_waitcnt lgkmcnt(4)
  v_pk_fma_f32 v[160:161], v[160:161], v[128:129], v[136:137]
  v_pk_fma_f32 v[162:163], v[162:163], v[130:131], v[138:139]
  v_cvt_pk_bf16_f32 v144, v156, v157
  v_cvt_pk_bf16_f32 v145, v158, v159
  v_cvt_pk_bf16_f32 v146, v160, v161
  v_cvt_pk_bf16_f32 v147, v162, v163
  s_waitcnt lgkmcnt(2)
  s_nop 0
  v_mfma_f32_32x32x16_bf16 v[60:75], v[100:103], v[144:147], v[60:75]
  s_waitcnt lgkmcnt(0)
  v_mfma_f32_32x32x16_bf16 v[76:91], v[104:107], v[144:147], v[76:91]
  ds_read_b128 v[108:111], v21 offset:256
  ds_read_b128 v[112:115], v21 offset:272
  ds_read_b128 v[116:119], v21 offset:288
  ds_read_b128 v[120:123], v21 offset:304
  ds_read_b64_tr_b16 v[92:93], v19 offset:4096
  ds_read_b64_tr_b16 v[94:95], v19 offset:4608
  ds_read_b64_tr_b16 v[96:97], v20 offset:4096
  ds_read_b64_tr_b16 v[98:99], v20 offset:4608
  ds_read_b128 v[124:127], v21 offset:384
  ds_read_b128 v[128:131], v21 offset:400
  ds_read_b128 v[132:135], v21 offset:416
  ds_read_b128 v[136:139], v21 offset:432
  ds_read_b64_tr_b16 v[100:101], v19 offset:6144
  ds_read_b64_tr_b16 v[102:103], v19 offset:6656
  ds_read_b64_tr_b16 v[104:105], v20 offset:6144
  s_waitcnt lgkmcnt(14)
  ds_read_b64_tr_b16 v[106:107], v20 offset:6656
  v_lshlrev_b32 v148, 16, v36
  v_and_b32 v149, 0xffff0000, v36
  v_lshlrev_b32 v150, 16, v37
  v_and_b32 v151, 0xffff0000, v37
  v_lshlrev_b32 v152, 16, v38
  v_and_b32 v153, 0xffff0000, v38
  v_lshlrev_b32 v154, 16, v39
  v_and_b32 v155, 0xffff0000, v39
  v_lshlrev_b32 v156, 16, v40
  v_and_b32 v157, 0xffff0000, v40
  v_lshlrev_b32 v158, 16, v41
  v_and_b32 v159, 0xffff0000, v41
  v_lshlrev_b32 v160, 16, v42
  v_and_b32 v161, 0xffff0000, v42
  v_lshlrev_b32 v162, 16, v43
  v_and_b32 v163, 0xffff0000, v43
  s_cmp_ge_u32 s27, 6
  s_cbranch_scc1 P3_NH01
  buffer_load_dwordx4 v[36:39], v4, s[20:23], s28 offen sc1
  buffer_load_dwordx4 v[40:43], v4, s[20:23], s28 offen offset:1024 sc1
  s_add_u32 s28, s28, 2048
  s_add_u32 s100, s100, 1
  s_cmp_eq_u32 s100, 8
  s_cselect_b32 s101, 32768, 0
  s_cselect_b32 s100, 0, s100
  s_sub_u32 s28, s28, s101
P3_NH01:
  s_waitcnt lgkmcnt(13)
  v_pk_fma_f32 v[148:149], v[148:149], v[108:109], v[116:117]
  v_pk_fma_f32 v[150:151], v[150:151], v[110:111], v[118:119]
  s_waitcnt lgkmcnt(12)
  v_pk_fma_f32 v[152:153], v[152:153], v[112:113], v[120:121]
  v_pk_fma_f32 v[154:155], v[154:155], v[114:115], v[122:123]
  v_cvt_pk_bf16_f32 v140, v148, v149
  v_cvt_pk_bf16_f32 v141, v150, v151
  v_cvt_pk_bf16_f32 v142, v152, v153
  v_cvt_pk_bf16_f32 v143, v154, v155
  s_waitcnt lgkmcnt(10)
  s_nop 0
  v_mfma_f32_32x32x16_bf16 v[60:75], v[92:95], v[140:143], v[60:75]
  s_waitcnt lgkmcnt(8)
  v_mfma_f32_32x32x16_bf16 v[76:91], v[96:99], v[140:143], v[76:91]
  s_waitcnt lgkmcnt(5)
  v_pk_fma_f32 v[156:157], v[156:157], v[124:125], v[132:133]
  v_pk_fma_f32 v[158:159], v[158:159], v[126:127], v[134:135]
  s_waitcnt lgkmcnt(4)
  v_pk_fma_f32 v[160:161], v[160:161], v[128:129], v[136:137]
  v_pk_fma_f32 v[162:163], v[162:163], v[130:131], v[138:139]
  v_cvt_pk_bf16_f32 v144, v156, v157
  v_cvt_pk_bf16_f32 v145, v158, v159
  v_cvt_pk_bf16_f32 v146, v160, v161
  v_cvt_pk_bf16_f32 v147, v162, v163
  s_waitcnt lgkmcnt(2)
  s_nop 0
  v_mfma_f32_32x32x16_bf16 v[60:75], v[100:103], v[144:147], v[60:75]
  s_waitcnt lgkmcnt(0)
  v_mfma_f32_32x32x16_bf16 v[76:91], v[104:107], v[144:147], v[76:91]
  s_add_u32 s67, s67, 8192
  s_cmp_eq_u32 s67, 24576
  s_cselect_b32 s67, 0, s67
  s_add_u32 s27, s27, 1
  s_cmp_eq_u32 s27, 7
  s_cbranch_scc1 P3T1_ALT
  s_waitcnt vmcnt(4)
P3T1_RET:
  s_waitcnt lgkmcnt(0)
  s_barrier
  s_add_u32 s29, s27, s7
  s_and_b32 s29, s29, 7
  s_lshl_b32 s29, s29, 9
  v_add_u32 v21, s29, v22
  v_add_u32 v19, s67, v17
  v_add_u32 v20, s67, v18
  ds_read_b128 v[108:111], v21 offset:0
  ds_read_b128 v[112:115], v21 offset:16
  ds_read_b128 v[116:119], v21 offset:32
  ds_read_b128 v[120:123], v21 offset:48
  ds_read_b64_tr_b16 v[92:93], v19 offset:0
  ds_read_b64_tr_b16 v[94:95], v19 offset:512
  ds_read_b64_tr_b16 v[96:97], v20 offset:0
  ds_read_b64_tr_b16 v[98:99], v20 offset:512
  ds_read_b128 v[124:127], v21 offset:128
  ds_read_b128 v[128:131], v21 offset:144
  ds_read_b128 v[132:135], v21 offset:160
  ds_read_b128 v[136:139], v21 offset:176
  ds_read_b64_tr_b16 v[100:101], v19 offset:2048
  ds_read_b64_tr_b16 v[102:103], v19 offset:2560
  ds_read_b64_tr_b16 v[104:105], v20 offset:2048
  s_waitcnt lgkmcnt(14)
  ds_read_b64_tr_b16 v[106:107], v20 offset:2560
  v_lshlrev_b32 v148, 16, v44
  v_and_b32 v149, 0xffff0000, v44
  v_lshlrev_b32 v150, 16, v45
  v_and_b32 v151, 0xffff0000, v45
  v_lshlrev_b32 v152, 16, v46
  v_and_b32 v153, 0xffff0000, v46
  v_lshlrev_b32 v154, 16, v47
  v_and_b32 v155, 0xffff0000, v47
  v_lshlrev_b32 v156, 16, v48
  v_and_b32 v157, 0xffff0000, v48
  v_lshlrev_b32 v158, 16, v49
  v_and_b32 v159, 0xffff0000, v49
  v_lshlrev_b32 v160, 16, v50
  v_and_b32 v161, 0xffff0000, v50
  v_lshlrev_b32 v162, 16, v51
  v_and_b32 v163, 0xffff0000, v51
  s_cmp_ge_u32 s27, 6
  s_cbranch_scc1 P3_NH10
  buffer_load_dwordx4 v[44:47], v4, s[20:23], s28 offen sc1
  buffer_load_dwordx4 v[48:51], v4, s[20:23], s28 offen offset:1024 sc1
  s_add_u32 s28, s28, 2048
P3_NH10:
  s_waitcnt lgkmcnt(13)
  v_pk_fma_f32 v[148:149], v[148:149], v[108:109], v[116:117]
  v_pk_fma_f32 v[150:151], v[150:151], v[110:111], v[118:119]
  s_waitcnt lgkmcnt(12)
  v_pk_fma_f32 v[152:153], v[152:153], v[112:113], v[120:121]
  v_pk_fma_f32 v[154:155], v[154:155], v[114:115], v[122:123]
  v_cvt_pk_bf16_f32 v140, v148, v149
  v_cvt_pk_bf16_f32 v141, v150, v151
  v_cvt_pk_bf16_f32 v142, v152, v153
  v_cvt_pk_bf16_f32 v143, v154, v155
  s_waitcnt lgkmcnt(10)
  s_nop 0
  v_mfma_f32_32x32x16_bf16 v[60:75], v[92:95], v[140:143], v[60:75]
  s_waitcnt lgkmcnt(8)
  v_mfma_f32_32x32x16_bf16 v[76:91], v[96:99], v[140:143], v[76:91]
  s_waitcnt lgkmcnt(5)
  v_pk_fma_f32 v[156:157], v[156:157], v[124:125], v[132:133]
  v_pk_fma_f32 v[158:159], v[158:159], v[126:127], v[134:135]
  s_waitcnt lgkmcnt(4)
  v_pk_fma_f32 v[160:161], v[160:161], v[128:129], v[136:137]
  v_pk_fma_f32 v[162:163], v[162:163], v[130:131], v[138:139]
  v_cvt_pk_bf16_f32 v144, v156, v157
  v_cvt_pk_bf16_f32 v145, v158, v159
  v_cvt_pk_bf16_f32 v146, v160, v161
  v_cvt_pk_bf16_f32 v147, v162, v163
  s_waitcnt lgkmcnt(2)
  s_nop 0
  v_mfma_f32_32x32x16_bf16 v[60:75], v[100:103], v[144:147], v[60:75]
  s_waitcnt lgkmcnt(0)
  v_mfma_f32_32x32x16_bf16 v[76:91], v[104:107], v[144:147], v[76:91]
  ds_read_b128 v[108:111], v21 offset:256
  ds_read_b128 v[112:115], v21 offset:272
  ds_read_b128 v[116:119], v21 offset:288
  ds_read_b128 v[120:123], v21 offset:304
  ds_read_b64_tr_b16 v[92:93], v19 offset:4096
  ds_read_b64_tr_b16 v[94:95], v19 offset:4608
  ds_read_b64_tr_b16 v[96:97], v20 offset:4096
  ds_read_b64_tr_b16 v[98:99], v20 offset:4608
  ds_read_b128 v[124:127], v21 offset:384
  ds_read_b128 v[128:131], v21 offset:400
  ds_read_b128 v[132:135], v21 offset:416
  ds_read_b128 v[136:139], v21 offset:432
  ds_read_b64_tr_b16 v[100:101], v19 offset:6144
  ds_read_b64_tr_b16 v[102:103], v19 offset:6656
  ds_read_b64_tr_b16 v[104:105], v20 offset:6144
  s_waitcnt lgkmcnt(14)
  ds_read_b64_tr_b16 v[106:107], v20 offset:6656
  v_lshlrev_b32 v148, 16, v52
  v_and_b32 v149, 0xffff0000, v52
  v_lshlrev_b32 v150, 16, v53
  v_and_b32 v151, 0xffff0000, v53
  v_lshlrev_b32 v152, 16, v54
  v_and_b32 v153, 0xffff0000, v54
  v_lshlrev_b32 v154, 16, v55
  v_and_b32 v155, 0xffff0000, v55
  v_lshlrev_b32 v156, 16, v56
  v_and_b32 v157, 0xffff0000, v56
  v_lshlrev_b32 v158, 16, v57
  v_and_b32 v159, 0xffff0000, v57
  v_lshlrev_b32 v160, 16, v58
  v_and_b32 v161, 0xffff0000, v58
  v_lshlrev_b32 v162, 16, v59
  v_and_b32 v163, 0xffff0000, v59
  s_cmp_ge_u32 s27, 6
  s_cbranch_scc1 P3_NH11
  buffer_load_dwordx4 v[52:55], v4, s[20:23], s28 offen sc1
  buffer_load_dwordx4 v[56:59], v4, s[20:23], s28 offen offset:1024 sc1
  s_add_u32 s28, s28, 2048
  s_add_u32 s100, s100, 1
  s_cmp_eq_u32 s100, 8
  s_cselect_b32 s101, 32768, 0
  s_cselect_b32 s100, 0, s100
  s_sub_u32 s28, s28, s101
P3_NH11:
  s_waitcnt lgkmcnt(13)
  v_pk_fma_f32 v[148:149], v[148:149], v[108:109], v[116:117]
  v_pk_fma_f32 v[150:151], v[150:151], v[110:111], v[118:119]
  s_waitcnt lgkmcnt(12)
  v_pk_fma_f32 v[152:153], v[152:153], v[112:113], v[120:121]
  v_pk_fma_f32 v[154:155], v[154:155], v[114:115], v[122:123]
  v_cvt_pk_bf16_f32 v140, v148, v149
  v_cvt_pk_bf16_f32 v141, v150, v151
  v_cvt_pk_bf16_f32 v142, v152, v153
  v_cvt_pk_bf16_f32 v143, v154, v155
  s_waitcnt lgkmcnt(10)
  s_nop 0
  v_mfma_f32_32x32x16_bf16 v[60:75], v[92:95], v[140:143], v[60:75]
  s_waitcnt lgkmcnt(8)
  v_mfma_f32_32x32x16_bf16 v[76:91], v[96:99], v[140:143], v[76:91]
  s_waitcnt lgkmcnt(5)
  v_pk_fma_f32 v[156:157], v[156:157], v[124:125], v[132:133]
  v_pk_fma_f32 v[158:159], v[158:159], v[126:127], v[134:135]
  s_waitcnt lgkmcnt(4)
  v_pk_fma_f32 v[160:161], v[160:161], v[128:129], v[136:137]
  v_pk_fma_f32 v[162:163], v[162:163], v[130:131], v[138:139]
  v_cvt_pk_bf16_f32 v144, v156, v157
  v_cvt_pk_bf16_f32 v145, v158, v159
  v_cvt_pk_bf16_f32 v146, v160, v161
  v_cvt_pk_bf16_f32 v147, v162, v163
  s_waitcnt lgkmcnt(2)
  s_nop 0
  v_mfma_f32_32x32x16_bf16 v[60:75], v[100:103], v[144:147], v[60:75]
  s_waitcnt lgkmcnt(0)
  v_mfma_f32_32x32x16_bf16 v[76:91], v[104:107], v[144:147], v[76:91]
  s_add_u32 s67, s67, 8192
  s_cmp_eq_u32 s67, 24576
  s_cselect_b32 s67, 0, s67
  s_add_u32 s27, s27, 1
  s_cmp_lt_u32 s27, 8
  s_cbranch_scc1 P3_LOOP
  s_branch P3_DONE
P3T1_ALT:
  s_waitcnt vmcnt(0)
  s_branch P3T1_RET
P3_DONE:
  s_lshl_b32 s29, s24, 13
  s_add_u32 s29, s29, 98304
  v_add_u32 v5, s29, v4
  s_lshl_b32 s29, s57, 15
  s_lshl_b32 s30, s56, 11
  s_add_u32 s29, s29, s30
  s_add_u32 s29, s29, 98304
  v_add_u32 v6, s29, v4
  s_barrier
  ds_write_b128 v5, v[60:63] offset:0
  ds_write_b128 v5, v[64:67] offset:1024
  ds_write_b128 v5, v[68:71] offset:2048
  ds_write_b128 v5, v[72:75] offset:3072
  ds_write_b128 v5, v[76:79] offset:4096
  ds_write_b128 v5, v[80:83] offset:5120
  ds_write_b128 v5, v[84:87] offset:6144
  ds_write_b128 v5, v[88:91] offset:7168
  v_lshlrev_b32 v108, 16, v24
  v_and_b32 v109, 0xffff0000, v24
  v_lshlrev_b32 v110, 16, v25
  v_and_b32 v111, 0xffff0000, v25
  v_lshlrev_b32 v112, 16, v26
  v_and_b32 v113, 0xffff0000, v26
  v_lshlrev_b32 v114, 16, v27
  v_and_b32 v115, 0xffff0000, v27
  v_bfe_u32 v5, v1, 4, 1
  v_mul_u32_u24 v5, 49152, v5
  v_lshl_add_u32 v5, v16, 8, v5
  v_lshl_add_u32 v5, v2, 4, v5
  s_lshl_b32 s30, s33, 1
  s_add_u32 s29, s57, s30
  s_mul_i32 s29, s29, 96
  s_lshl_b32 s30, s34, 1
  s_add_u32 s29, s29, s30
  s_lshl_b32 s29, s29, 10
  s_lshl_b32 s30, s56, 9
  s_add_u32 s32, s29, s30
  s_mov_b32 s29, 0xbdd2d3e8
  v_mov_b32 v8, 0xc0135761
  s_waitcnt lgkmcnt(0)
  s_barrier
  ds_read_b128 v[60:63], v6 offset:0
  ds_read_b128 v[68:71], v6 offset:8192
  ds_read_b128 v[76:79], v6 offset:16384
  ds_read_b128 v[84:87], v6 offset:24576
  ds_read_b128 v[64:67], v6 offset:1024
  ds_read_b128 v[72:75], v6 offset:9216
  ds_read_b128 v[80:83], v6 offset:17408
  ds_read_b128 v[88:91], v6 offset:25600
  s_waitcnt lgkmcnt(6)
  v_pk_add_f32 v[60:61], v[60:61], v[68:69]
  s_waitcnt lgkmcnt(4)
  v_pk_add_f32 v[76:77], v[76:77], v[84:85]
  v_pk_add_f32 v[60:61], v[60:61], v[108:109]
  v_pk_add_f32 v[60:61], v[60:61], v[76:77]
  v_pk_mul_f32 v[124:125], v[60:61], v[60:61]
  v_fma_f32 v124, v124, s29, v8
  v_fma_f32 v125, v125, s29, v8
  v_pk_mul_f32 v[124:125], v[124:125], v[60:61]
  v_exp_f32 v124, v124
  v_exp_f32 v125, v125
  v_pk_add_f32 v[62:63], v[62:63], v[70:71]
  v_pk_add_f32 v[78:79], v[78:79], v[86:87]
  v_pk_add_f32 v[62:63], v[62:63], v[110:111]
  v_pk_add_f32 v[62:63], v[62:63], v[78:79]
  v_pk_mul_f32 v[126:127], v[62:63], v[62:63]
  v_fma_f32 v126, v126, s29, v8
  v_fma_f32 v127, v127, s29, v8
  v_pk_mul_f32 v[126:127], v[126:127], v[62:63]
  v_exp_f32 v126, v126
  v_exp_f32 v127, v127
  s_waitcnt lgkmcnt(2)
  v_pk_add_f32 v[64:65], v[64:65], v[72:73]
  s_waitcnt lgkmcnt(0)
  v_pk_add_f32 v[80:81], v[80:81], v[88:89]
  v_pk_add_f32 v[64:65], v[64:65], v[112:113]
  v_pk_add_f32 v[64:65], v[64:65], v[80:81]
  v_pk_mul_f32 v[128:129], v[64:65], v[64:65]
  v_fma_f32 v128, v128, s29, v8
  v_fma_f32 v129, v129, s29, v8
  v_pk_mul_f32 v[128:129], v[128:129], v[64:65]
  v_exp_f32 v128, v128
  v_exp_f32 v129, v129
  v_pk_add_f32 v[66:67], v[66:67], v[74:75]
  v_pk_add_f32 v[82:83], v[82:83], v[90:91]
  v_pk_add_f32 v[66:67], v[66:67], v[114:115]
  v_pk_add_f32 v[66:67], v[66:67], v[82:83]
  v_pk_mul_f32 v[130:131], v[66:67], v[66:67]
  v_fma_f32 v130, v130, s29, v8
  v_fma_f32 v131, v131, s29, v8
  v_pk_mul_f32 v[130:131], v[130:131], v[66:67]
  v_exp_f32 v130, v130
  v_exp_f32 v131, v131
  v_add_f32 v124, 1.0, v124
  v_rcp_f32 v124, v124
  v_add_f32 v125, 1.0, v125
  v_rcp_f32 v125, v125
  v_add_f32 v126, 1.0, v126
  v_rcp_f32 v126, v126
  v_add_f32 v127, 1.0, v127
  v_rcp_f32 v127, v127
  v_add_f32 v128, 1.0, v128
  v_rcp_f32 v128, v128
  v_add_f32 v129, 1.0, v129
  v_rcp_f32 v129, v129
  v_add_f32 v130, 1.0, v130
  v_rcp_f32 v130, v130
  v_add_f32 v131, 1.0, v131
  v_rcp_f32 v131, v131
  v_pk_mul_f32 v[60:61], v[60:61], v[124:125]
  v_cvt_pk_bf16_f32 v140, v60, v61
  v_pk_mul_f32 v[62:63], v[62:63], v[126:127]
  v_cvt_pk_bf16_f32 v141, v62, v63
  v_pk_mul_f32 v[64:65], v[64:65], v[128:129]
  v_cvt_pk_bf16_f32 v142, v64, v65
  v_pk_mul_f32 v[66:67], v[66:67], v[130:131]
  v_cvt_pk_bf16_f32 v143, v66, v67
  buffer_store_dwordx4 v[140:143], v5, s[12:15], s32 offen sc1
  s_waitcnt vmcnt(0)
  s_barrier
  s_branch P4_START
P3_SKIP:
  s_mov_b32 s67, 16384
  s_barrier
P4_START:
  s_add_u32 s12, s92, 6291456
  s_addc_u32 s13, s93, 0
  s_mov_b32 s14, 1966080
  s_mov_b32 s15, 0x00020000
  s_mov_b32 s8, s86
  s_mov_b32 s9, s87
  s_mov_b32 s10, 4096
  s_mov_b32 s11, 0x00020000
  s_mov_b32 s16, s88
  s_mov_b32 s17, s89
  s_mov_b32 s18, 2621440
  s_mov_b32 s19, 0x00020000
  s_mov_b32 s22, 2621440
  s_mov_b32 s35, 0x80000000
  s_mul_i32 s29, s57, 147456
  v_add_u32 v16, s29, v4
  v_add_u32 v17, 49152, v16
  v_add_u32 v18, 98304, v4
  s_mul_i32 s36, s68, 5
  s_mul_i32 s28, s36, 48
  s_mul_i32 s29, s56, 12
  s_add_u32 s28, s28, s29
  s_lshl_b32 s28, s28, 10
  s_lshl_b32 s29, s71, 11
  s_add_u32 s28, s28, s29
  s_mov_b32 s100, s71
  s_lshl_b32 s29, s57, 10
  s_add_u32 s41, s28, s29
  s_sub_u32 s28, s28, s29
  s_add_u32 s28, s28, 1024
  v_lshlrev_b32 v7, 9, v3
  v_lshl_add_u32 v7, v2, 4, v7
  v_lshlrev_b32 v8, 1, v2
  s_lshl_b32 s29, s69, 2
  s_add_u32 s37, s29, s56
  s_lshl_b32 s30, s37, 5
  buffer_load_ushort v30, v8, s[8:11], s30 offen
  s_and_b32 s31, s37, 0xfffffffe
  s_mul_i32 s42, s57, 3
  s_add_u32 s42, s42, s36
  s_add_u32 s29, s42, 0
  s_lshr_b32 s30, s29, 1
  s_lshl_b32 s30, s30, 7
  s_add_u32 s30, s30, s31
  s_lshl_b32 s30, s30, 10
  s_and_b32 s29, s29, 1
  s_lshl_b32 s29, s29, 8
  s_add_u32 s30, s30, s29
  buffer_load_dwordx4 v[32:35], v7, s[20:23], s30 offen sc1
  s_add_u32 s29, s42, 1
  s_lshr_b32 s30, s29, 1
  s_lshl_b32 s30, s30, 7
  s_add_u32 s30, s30, s31
  s_lshl_b32 s30, s30, 10
  s_and_b32 s29, s29, 1
  s_lshl_b32 s29, s29, 8
  s_add_u32 s30, s30, s29
  buffer_load_dwordx4 v[36:39], v7, s[20:23], s30 offen sc1
  s_add_u32 s29, s36, 2
  s_lshr_b32 s30, s29, 1
  s_lshl_b32 s30, s30, 7
  s_add_u32 s30, s30, s31
  s_lshl_b32 s30, s30, 10
  s_and_b32 s29, s29, 1
  s_lshl_b32 s29, s29, 8
  s_add_u32 s30, s30, s29
  buffer_load_dwordx4 v[40:43], v7, s[20:23], s30 offen sc1
  s_lshl_b32 s29, s37, 4
  v_add_u32 v5, s29, v2
  v_mul_u32_u24 v5, 1280, v5
  v_lshl_add_u32 v5, v3, 3, v5
  s_lshl_b32 s29, s42, 5
  v_add_u32 v27, s29, v5
  s_cmp_eq_u32 s57, 0
  s_cselect_b32 s29, 64, s35
  v_add_u32 v28, s29, v27
  s_and_b32 s31, s24, 1
  s_lshl_b32 s31, s31, 1
  v_bfe_u32 v5, v1, 2, 2
  v_and_b32 v6, 1, v3
  v_lshl_add_u32 v7, v6, 2, v5
  v_lshrrev_b32 v8, 1, v3
  v_lshl_add_u32 v7, v8, 4, v7
  v_lshlrev_b32 v7, 7, v7
  v_lshrrev_b32 v5, 1, v5
  v_lshl_add_u32 v5, v6, 1, v5
  v_lshl_add_u32 v7, v5, 5, v7
  v_and_b32 v6, 3, v1
  v_lshl_add_u32 v7, v6, 3, v7
  s_lshl_b32 s29, s57, 12
  s_add_u32 s29, s29, s66
  v_xor_b32 v5, 0, v7
  v_add_u32 v19, s29, v5
  v_xor_b32 v5, 32, v7
  v_add_u32 v20, s29, v5
  v_xor_b32 v5, 64, v7
  v_add_u32 v21, s29, v5
  v_xor_b32 v5, 96, v7
  v_add_u32 v22, s29, v5
  v_mov_b32 v84, 0
  v_mov_b32 v85, 0
  v_mov_b32 v86, 0
  v_mov_b32 v87, 0
  v_mov_b32 v88, 0
  v_mov_b32 v89, 0
  v_mov_b32 v90, 0
  v_mov_b32 v91, 0
  v_mov_b32 v92, 0
  v_mov_b32 v93, 0
  v_mov_b32 v94, 0
  v_mov_b32 v95, 0
  v_mov_b32 v96, 0
  v_mov_b32 v97, 0
  v_mov_b32 v98, 0
  v_mov_b32 v99, 0
  v_mov_b32 v100, 0
  v_mov_b32 v101, 0
  v_mov_b32 v102, 0
  v_mov_b32 v103, 0
  v_mov_b32 v104, 0
  v_mov_b32 v105, 0
  v_mov_b32 v106, 0
  v_mov_b32 v107, 0
  v_mov_b32 v108, 0
  v_mov_b32 v109, 0
  v_mov_b32 v110, 0
  v_mov_b32 v111, 0
  v_mov_b32 v112, 0
  v_mov_b32 v113, 0
  v_mov_b32 v114, 0
  v_mov_b32 v115, 0
  v_mov_b32 v116, 0
  v_mov_b32 v117, 0
  v_mov_b32 v118, 0
  v_mov_b32 v119, 0
  v_mov_b32 v120, 0
  v_mov_b32 v121, 0
  v_mov_b32 v122, 0
  v_mov_b32 v123, 0
  v_mov_b32 v124, 0
  v_mov_b32 v125, 0
  v_mov_b32 v126, 0
  v_mov_b32 v127, 0
  v_mov_b32 v128, 0
  v_mov_b32 v129, 0
  v_mov_b32 v130, 0
  v_mov_b32 v131, 0
  s_mov_b32 s27, 0
  s_barrier
  buffer_load_dwordx4 v[44:47], v16, s[12:15], s41 offen sc1
  buffer_load_dwordx4 v[48:51], v17, s[12:15], s41 offen sc1
  buffer_load_dwordx4 v[52:55], v18, s[12:15], s41 offen sc1
  s_add_u32 s41, s41, 2048
  buffer_load_dwordx4 v[56:59], v16, s[12:15], s28 offen sc1
  buffer_load_dwordx4 v[60:63], v17, s[12:15], s28 offen sc1
  s_add_u32 s28, s28, 2048
  s_add_u32 s100, s100, 1
  s_cmp_eq_u32 s100, 6
  s_cselect_b32 s101, 12288, 0
  s_cselect_b32 s100, 0, s100
  s_sub_u32 s41, s41, s101
  s_sub_u32 s28, s28, s101
  buffer_load_dwordx4 v[64:67], v16, s[12:15], s41 offen sc1
  buffer_load_dwordx4 v[68:71], v17, s[12:15], s41 offen sc1
  buffer_load_dwordx4 v[72:75], v18, s[12:15], s41 offen sc1
  s_add_u32 s41, s41, 2048
  buffer_load_dwordx4 v[76:79], v16, s[12:15], s28 offen sc1
  buffer_load_dwordx4 v[80:83], v17, s[12:15], s28 offen sc1
  s_add_u32 s28, s28, 2048
  s_add_u32 s100, s100, 1
  s_cmp_eq_u32 s100, 6
  s_cselect_b32 s101, 12288, 0
  s_cselect_b32 s100, 0, s100
  s_sub_u32 s41, s41, s101
  s_sub_u32 s28, s28, s101
P4_LOOP:
  s_waitcnt vmcnt(5)
  s_waitcnt lgkmcnt(0)
  s_barrier
  v_add_u32 v23, s67, v19
  v_add_u32 v24, s67, v20
  v_add_u32 v25, s67, v21
  v_add_u32 v26, s67, v22
  ds_read_b64_tr_b16 v[132:133], v23 offset:0
  ds_read_b64_tr_b16 v[134:135], v23 offset:1024
  ds_read_b64_tr_b16 v[136:137], v24 offset:0
  ds_read_b64_tr_b16 v[138:139], v24 offset:1024
  ds_read_b64_tr_b16 v[140:141], v25 offset:0
  ds_read_b64_tr_b16 v[142:143], v25 offset:1024
  ds_read_b64_tr_b16 v[144:145], v26 offset:0
  ds_read_b64_tr_b16 v[146:147], v26 offset:1024
  v_xor_b32 v23, 4096, v23
  v_xor_b32 v24, 4096, v24
  v_xor_b32 v25, 4096, v25
  v_xor_b32 v26, 4096, v26
  ds_read_b64_tr_b16 v[148:149], v23 offset:0
  ds_read_b64_tr_b16 v[150:151], v23 offset:1024
  ds_read_b64_tr_b16 v[152:153], v24 offset:0
  ds_read_b64_tr_b16 v[154:155], v24 offset:1024
  ds_read_b64_tr_b16 v[156:157], v25 offset:0
  ds_read_b64_tr_b16 v[158:159], v25 offset:1024
  ds_read_b64_tr_b16 v[160:161], v26 offset:0
  s_waitcnt lgkmcnt(14)
  ds_read_b64_tr_b16 v[162:163], v26 offset:1024
  s_waitcnt lgkmcnt(14)
  v_mfma_f32_16x16x32_bf16 v[84:87], v[44:47], v[132:135], v[84:87]
  v_mfma_f32_16x16x32_bf16 v[100:103], v[48:51], v[132:135], v[100:103]
  v_mfma_f32_16x16x32_bf16 v[116:119], v[52:55], v[132:135], v[116:119]
  s_waitcnt lgkmcnt(12)
  v_mfma_f32_16x16x32_bf16 v[88:91], v[44:47], v[136:139], v[88:91]
  v_mfma_f32_16x16x32_bf16 v[104:107], v[48:51], v[136:139], v[104:107]
  v_mfma_f32_16x16x32_bf16 v[120:123], v[52:55], v[136:139], v[120:123]
  s_waitcnt lgkmcnt(10)
  v_mfma_f32_16x16x32_bf16 v[92:95], v[44:47], v[140:143], v[92:95]
  v_mfma_f32_16x16x32_bf16 v[108:111], v[48:51], v[140:143], v[108:111]
  v_mfma_f32_16x16x32_bf16 v[124:127], v[52:55], v[140:143], v[124:127]
  s_waitcnt lgkmcnt(8)
  v_mfma_f32_16x16x32_bf16 v[96:99], v[44:47], v[144:147], v[96:99]
  v_mfma_f32_16x16x32_bf16 v[112:115], v[48:51], v[144:147], v[112:115]
  v_mfma_f32_16x16x32_bf16 v[128:131], v[52:55], v[144:147], v[128:131]
  s_cmp_ge_u32 s27, 4
  s_cbranch_scc1 P4_NG00
  buffer_load_dwordx4 v[44:47], v16, s[12:15], s41 offen sc1
  buffer_load_dwordx4 v[48:51], v17, s[12:15], s41 offen sc1
  buffer_load_dwordx4 v[52:55], v18, s[12:15], s41 offen sc1
  s_add_u32 s41, s41, 2048
P4_NG00:
  s_waitcnt lgkmcnt(6)
  v_mfma_f32_16x16x32_bf16 v[84:87], v[56:59], v[148:151], v[84:87]
  v_mfma_f32_16x16x32_bf16 v[100:103], v[60:63], v[148:151], v[100:103]
  s_waitcnt lgkmcnt(4)
  v_mfma_f32_16x16x32_bf16 v[88:91], v[56:59], v[152:155], v[88:91]
  v_mfma_f32_16x16x32_bf16 v[104:107], v[60:63], v[152:155], v[104:107]
  s_waitcnt lgkmcnt(2)
  v_mfma_f32_16x16x32_bf16 v[92:95], v[56:59], v[156:159], v[92:95]
  v_mfma_f32_16x16x32_bf16 v[108:111], v[60:63], v[156:159], v[108:111]
  s_waitcnt lgkmcnt(0)
  v_mfma_f32_16x16x32_bf16 v[96:99], v[56:59], v[160:163], v[96:99]
  v_mfma_f32_16x16x32_bf16 v[112:115], v[60:63], v[160:163], v[112:115]
  s_cmp_ge_u32 s27, 4
  s_cbranch_scc1 P4_NG01
  buffer_load_dwordx4 v[56:59], v16, s[12:15], s28 offen sc1
  buffer_load_dwordx4 v[60:63], v17, s[12:15], s28 offen sc1
  s_add_u32 s28, s28, 2048
  s_add_u32 s100, s100, 1
  s_cmp_eq_u32 s100, 6
  s_cselect_b32 s101, 12288, 0
  s_cselect_b32 s100, 0, s100
  s_sub_u32 s41, s41, s101
  s_sub_u32 s28, s28, s101
P4_NG01:
  s_add_u32 s67, s67, 8192
  s_cmp_eq_u32 s67, 24576
  s_cselect_b32 s67, 0, s67
  s_add_u32 s27, s27, 1
  s_cmp_eq_u32 s27, 5
  s_cbranch_scc1 P4T1_ALT
  s_waitcnt vmcnt(5)
P4T1_RET:
  s_waitcnt lgkmcnt(0)
  s_barrier
  v_add_u32 v23, s67, v19
  v_add_u32 v24, s67, v20
  v_add_u32 v25, s67, v21
  v_add_u32 v26, s67, v22
  ds_read_b64_tr_b16 v[132:133], v23 offset:0
  ds_read_b64_tr_b16 v[134:135], v23 offset:1024
  ds_read_b64_tr_b16 v[136:137], v24 offset:0
  ds_read_b64_tr_b16 v[138:139], v24 offset:1024
  ds_read_b64_tr_b16 v[140:141], v25 offset:0
  ds_read_b64_tr_b16 v[142:143], v25 offset:1024
  ds_read_b64_tr_b16 v[144:145], v26 offset:0
  ds_read_b64_tr_b16 v[146:147], v26 offset:1024
  v_xor_b32 v23, 4096, v23
  v_xor_b32 v24, 4096, v24
  v_xor_b32 v25, 4096, v25
  v_xor_b32 v26, 4096, v26
  ds_read_b64_tr_b16 v[148:149], v23 offset:0
  ds_read_b64_tr_b16 v[150:151], v23 offset:1024
  ds_read_b64_tr_b16 v[152:153], v24 offset:0
  ds_read_b64_tr_b16 v[154:155], v24 offset:1024
  ds_read_b64_tr_b16 v[156:157], v25 offset:0
  ds_read_b64_tr_b16 v[158:159], v25 offset:1024
  ds_read_b64_tr_b16 v[160:161], v26 offset:0
  s_waitcnt lgkmcnt(14)
  ds_read_b64_tr_b16 v[162:163], v26 offset:1024
  s_waitcnt lgkmcnt(14)
  v_mfma_f32_16x16x32_bf16 v[84:87], v[64:67], v[132:135], v[84:87]
  v_mfma_f32_16x16x32_bf16 v[100:103], v[68:71], v[132:135], v[100:103]
  v_mfma_f32_16x16x32_bf16 v[116:119], v[72:75], v[132:135], v[116:119]
  s_waitcnt lgkmcnt(12)
  v_mfma_f32_16x16x32_bf16 v[88:91], v[64:67], v[136:139], v[88:91]
  v_mfma_f32_16x16x32_bf16 v[104:107], v[68:71], v[136:139], v[104:107]
  v_mfma_f32_16x16x32_bf16 v[120:123], v[72:75], v[136:139], v[120:123]
  s_waitcnt lgkmcnt(10)
  v_mfma_f32_16x16x32_bf16 v[92:95], v[64:67], v[140:143], v[92:95]
  v_mfma_f32_16x16x32_bf16 v[108:111], v[68:71], v[140:143], v[108:111]
  v_mfma_f32_16x16x32_bf16 v[124:127], v[72:75], v[140:143], v[124:127]
  s_waitcnt lgkmcnt(8)
  v_mfma_f32_16x16x32_bf16 v[96:99], v[64:67], v[144:147], v[96:99]
  v_mfma_f32_16x16x32_bf16 v[112:115], v[68:71], v[144:147], v[112:115]
  v_mfma_f32_16x16x32_bf16 v[128:131], v[72:75], v[144:147], v[128:131]
  s_cmp_ge_u32 s27, 4
  s_cbranch_scc1 P4_NG10
  buffer_load_dwordx4 v[64:67], v16, s[12:15], s41 offen sc1
  buffer_load_dwordx4 v[68:71], v17, s[12:15], s41 offen sc1
  buffer_load_dwordx4 v[72:75], v18, s[12:15], s41 offen sc1
  s_add_u32 s41, s41, 2048
P4_NG10:
  s_waitcnt lgkmcnt(6)
  v_mfma_f32_16x16x32_bf16 v[84:87], v[76:79], v[148:151], v[84:87]
  v_mfma_f32_16x16x32_bf16 v[100:103], v[80:83], v[148:151], v[100:103]
  s_waitcnt lgkmcnt(4)
  v_mfma_f32_16x16x32_bf16 v[88:91], v[76:79], v[152:155], v[88:91]
  v_mfma_f32_16x16x32_bf16 v[104:107], v[80:83], v[152:155], v[104:107]
  s_waitcnt lgkmcnt(2)
  v_mfma_f32_16x16x32_bf16 v[92:95], v[76:79], v[156:159], v[92:95]
  v_mfma_f32_16x16x32_bf16 v[108:111], v[80:83], v[156:159], v[108:111]
  s_waitcnt lgkmcnt(0)
  v_mfma_f32_16x16x32_bf16 v[96:99], v[76:79], v[160:163], v[96:99]
  v_mfma_f32_16x16x32_bf16 v[112:115], v[80:83], v[160:163], v[112:115]
  s_cmp_ge_u32 s27, 4
  s_cbranch_scc1 P4_NG11
  buffer_load_dwordx4 v[76:79], v16, s[12:15], s28 offen sc1
  buffer_load_dwordx4 v[80:83], v17, s[12:15], s28 offen sc1
  s_add_u32 s28, s28, 2048
  s_add_u32 s100, s100, 1
  s_cmp_eq_u32 s100, 6
  s_cselect_b32 s101, 12288, 0
  s_cselect_b32 s100, 0, s100
  s_sub_u32 s41, s41, s101
  s_sub_u32 s28, s28, s101
P4_NG11:
  s_add_u32 s67, s67, 8192
  s_cmp_eq_u32 s67, 24576
  s_cselect_b32 s67, 0, s67
  s_add_u32 s27, s27, 1
  s_cmp_lt_u32 s27, 6
  s_cbranch_scc1 P4_LOOP
  s_branch P4_DONE
P4T1_ALT:
  s_waitcnt vmcnt(0)
  s_branch P4T1_RET
P4_DONE:
  s_mul_i32 s29, s24, 12288
  v_add_u32 v5, s29, v4
  s_mul_i32 s29, s57, 49152
  s_mul_i32 s30, s56, 3072
  s_add_u32 s29, s29, s30
  v_add_u32 v6, s29, v4
  s_xor_b32 s29, s57, 1
  s_mul_i32 s29, s29, 49152
  s_add_u32 s29, s29, s30
  v_add_u32 v7, s29, v4
  v_lshlrev_b32 v30, 16, v30
  s_waitcnt vmcnt(0)
  v_lshrrev_b32 v8, 3, v2
  v_add_u32 v8, s31, v8
  v_cmp_eq_u32 s[42:43], v8, v3
  v_and_b32 v8, 1, v2
  v_lshlrev_b32 v8, 4, v8
  v_mov_b32 v9, 0x3f80
  v_lshlrev_b32 v9, v8, v9
  v_cndmask_b32 v9, 0, v9, s[42:43]
  v_bfe_u32 v8, v2, 1, 2
  v_cmp_eq_u32 vcc, 0, v8
  s_nop 1
  v_cndmask_b32 v44, 0, v9, vcc
  v_cmp_eq_u32 vcc, 1, v8
  s_nop 1
  v_cndmask_b32 v45, 0, v9, vcc
  v_cmp_eq_u32 vcc, 2, v8
  s_nop 1
  v_cndmask_b32 v46, 0, v9, vcc
  v_cmp_eq_u32 vcc, 3, v8
  s_nop 1
  v_cndmask_b32 v47, 0, v9, vcc
  s_barrier
  ds_write_b128 v5, v[84:87] offset:0
  ds_write_b128 v5, v[100:103] offset:1024
  ds_write_b128 v5, v[116:119] offset:2048
  ds_write_b128 v5, v[88:91] offset:3072
  ds_write_b128 v5, v[104:107] offset:4096
  ds_write_b128 v5, v[120:123] offset:5120
  ds_write_b128 v5, v[92:95] offset:6144
  ds_write_b128 v5, v[108:111] offset:7168
  ds_write_b128 v5, v[124:127] offset:8192
  ds_write_b128 v5, v[96:99] offset:9216
  ds_write_b128 v5, v[112:115] offset:10240
  ds_write_b128 v5, v[128:131] offset:11264
  s_waitcnt lgkmcnt(0)
  s_barrier
  ds_read_b128 v[84:87], v6 offset:0
  ds_read_b128 v[88:91], v6 offset:12288
  ds_read_b128 v[92:95], v6 offset:24576
  ds_read_b128 v[96:99], v6 offset:36864
  ds_read_b128 v[100:103], v6 offset:1024
  ds_read_b128 v[104:107], v6 offset:13312
  ds_read_b128 v[108:111], v6 offset:25600
  ds_read_b128 v[112:115], v6 offset:37888
  ds_read_b128 v[116:119], v6 offset:2048
  ds_read_b128 v[120:123], v6 offset:14336
  ds_read_b128 v[124:127], v6 offset:26624
  ds_read_b128 v[128:131], v6 offset:38912
  ds_read_b128 v[132:135], v7 offset:2048
  ds_read_b128 v[136:139], v7 offset:14336
  ds_read_b128 v[140:143], v7 offset:26624
  s_waitcnt lgkmcnt(14)
  ds_read_b128 v[144:147], v7 offset:38912
  s_waitcnt lgkmcnt(14)
  v_pk_add_f32 v[84:85], v[84:85], v[88:89]
  s_waitcnt lgkmcnt(12)
  v_pk_add_f32 v[92:93], v[92:93], v[96:97]
  v_pk_add_f32 v[84:85], v[84:85], v[30:31] op_sel_hi:[1,0]
  s_nop 0
  v_pk_add_f32 v[84:85], v[84:85], v[92:93]
  v_pk_add_f32 v[86:87], v[86:87], v[90:91]
  v_pk_add_f32 v[94:95], v[94:95], v[98:99]
  v_pk_add_f32 v[86:87], v[86:87], v[30:31] op_sel_hi:[1,0]
  s_nop 0
  v_pk_add_f32 v[86:87], v[86:87], v[94:95]
  s_nop 1
  v_mfma_f32_16x16x32_bf16 v[84:87], v[32:35], v[44:47], v[84:87]
  s_waitcnt lgkmcnt(10)
  v_pk_add_f32 v[100:101], v[100:101], v[104:105]
  s_waitcnt lgkmcnt(8)
  v_pk_add_f32 v[108:109], v[108:109], v[112:113]
  v_pk_add_f32 v[100:101], v[100:101], v[30:31] op_sel_hi:[1,0]
  s_nop 0
  v_pk_add_f32 v[100:101], v[100:101], v[108:109]
  v_pk_add_f32 v[102:103], v[102:103], v[106:107]
  v_pk_add_f32 v[110:111], v[110:111], v[114:115]
  v_pk_add_f32 v[102:103], v[102:103], v[30:31] op_sel_hi:[1,0]
  s_nop 0
  v_pk_add_f32 v[102:103], v[102:103], v[110:111]
  s_nop 1
  v_mfma_f32_16x16x32_bf16 v[100:103], v[36:39], v[44:47], v[100:103]
  s_waitcnt lgkmcnt(6)
  v_pk_add_f32 v[116:117], v[116:117], v[120:121]
  s_waitcnt lgkmcnt(4)
  v_pk_add_f32 v[124:125], v[124:125], v[128:129]
  v_pk_add_f32 v[116:117], v[116:117], v[30:31] op_sel_hi:[1,0]
  s_nop 0
  v_pk_add_f32 v[116:117], v[116:117], v[124:125]
  s_waitcnt lgkmcnt(2)
  v_pk_add_f32 v[132:133], v[132:133], v[136:137]
  s_waitcnt lgkmcnt(0)
  v_pk_add_f32 v[140:141], v[140:141], v[144:145]
  v_pk_add_f32 v[116:117], v[116:117], v[132:133]
  v_pk_add_f32 v[116:117], v[116:117], v[140:141]
  v_pk_add_f32 v[118:119], v[118:119], v[122:123]
  v_pk_add_f32 v[126:127], v[126:127], v[130:131]
  v_pk_add_f32 v[118:119], v[118:119], v[30:31] op_sel_hi:[1,0]
  s_nop 0
  v_pk_add_f32 v[118:119], v[118:119], v[126:127]
  v_pk_add_f32 v[134:135], v[134:135], v[138:139]
  v_pk_add_f32 v[142:143], v[142:143], v[146:147]
  v_pk_add_f32 v[118:119], v[118:119], v[134:135]
  v_pk_add_f32 v[118:119], v[118:119], v[142:143]
  s_nop 1
  v_mfma_f32_16x16x32_bf16 v[116:119], v[40:43], v[44:47], v[116:119]
  v_cvt_pk_bf16_f32 v84, v84, v85
  v_cvt_pk_bf16_f32 v85, v86, v87
  buffer_store_dwordx2 v[84:85], v27, s[16:19], 0 offen offset:0
  v_cvt_pk_bf16_f32 v100, v100, v101
  v_cvt_pk_bf16_f32 v101, v102, v103
  buffer_store_dwordx2 v[100:101], v27, s[16:19], 0 offen offset:32
  s_nop 1
  v_cvt_pk_bf16_f32 v116, v116, v117
  v_cvt_pk_bf16_f32 v117, v118, v119
  buffer_store_dwordx2 v[116:117], v28, s[16:19], 0 offen
  s_endpgm
HELPER:
  s_sub_u32 s67, s24, 8
  v_mov_b32 v17, 0x80000000
  v_cmp_eq_u32 vcc, 0, v1
  s_nop 1
  v_cndmask_b32 v12, v17, 0, vcc
  s_lshr_b32 s27, s25, 1
  s_lshl_b32 s27, s27, 2
  s_lshr_b32 s28, s26, 3
  s_add_u32 s65, s27, s28
  s_and_b32 s27, s25, 1
  s_lshl_b32 s27, s27, 3
  s_and_b32 s28, s26, 7
  s_mul_i32 s42, s28, 160
  s_add_u32 s66, s27, s28
  s_lshl_b32 s35, s65, 7
  s_sub_u32 s35, s35, 16
  s_mul_i32 s35, s35, 1280
  s_mul_i32 s41, s66, 80
  v_lshrrev_b32 v5, 3, v1
  v_mul_u32_u24 v5, 1280, v5
  v_and_b32 v7, 7, v1
  v_xor_b32 v6, v3, v7
  v_lshl_add_u32 v28, v6, 4, v5
  s_and_b32 s27, s67, 1
  s_lshl_b32 s27, s27, 6
  v_xor_b32 v28, s27, v28
  s_mul_i32 s27, s67, 10240
  s_add_u32 s35, s35, s27
  s_mul_i32 s27, s67, 61440
  s_add_u32 s41, s41, s27
  s_lshl_b32 s27, s67, 12
  s_lshl_b32 s68, s67, 10
  s_add_u32 s69, s27, 18432
  v_lshrrev_b32 v6, 1, v2
  v_xor_b32 v5, v3, v6
  v_and_b32 v6, 1, v2
  v_lshl_add_u32 v5, v5, 1, v6
  v_cmp_ne_u32 s[70:71], 15, v5
  v_mul_u32_u24 v6, 13, v5
  v_lshrrev_b32 v6, 6, v6
  v_mul_u32_u24 v6, 1200, v6
  v_lshl_add_u32 v6, v5, 4, v6
  v_mul_u32_u24 v7, 3840, v3
  v_add_u32 v6, v6, v7
  v_add_u32 v45, 0, v6
  v_add_u32 v46, 14336, v6
  v_lshrrev_b32 v6, 1, v2
  v_xor_b32 v5, v3, v6
  v_xor_b32 v5, 4, v5
  v_and_b32 v6, 1, v2
  v_lshl_add_u32 v5, v5, 1, v6
  v_cmp_ne_u32 s[4:5], 15, v5
  v_mul_u32_u24 v6, 13, v5
  v_lshrrev_b32 v6, 6, v6
  v_mul_u32_u24 v6, 1200, v6
  v_lshl_add_u32 v6, v5, 4, v6
  v_mul_u32_u24 v7, 3840, v3
  v_add_u32 v6, v6, v7
  v_add_u32 v47, 28672, v6
  v_add_u32 v48, 43008, v6
  s_mov_b32 s32, 0
  s_mov_b32 s33, 35840
  s_mov_b32 s34, 71680
  s_waitcnt lgkmcnt(0)
  s_mov_b32 s8, s72
  s_mov_b32 s9, s73
  s_mov_b32 s10, 2621440
  s_mov_b32 s11, 0x00020000
  s_mov_b32 s12, s74
  s_mov_b32 s13, s75
  s_mov_b32 s14, 2457600
  s_mov_b32 s15, 0x00020000
  s_add_u32 m0, s32, s69
  s_mov_b64 exec, s[70:71]
  buffer_load_dwordx4 v45, s[12:15], s41 offen offset:0 lds
  buffer_load_dwordx4 v46, s[12:15], s41 offen offset:1024 lds
  s_mov_b64 exec, s[4:5]
  buffer_load_dwordx4 v47, s[12:15], s41 offen offset:2048 lds
  buffer_load_dwordx4 v48, s[12:15], s41 offen offset:3072 lds
  s_mov_b64 exec, -1
  s_add_u32 s41, s41, 245760
  s_add_u32 s28, s32, s68
  s_mov_b32 s27, s35
  s_add_u32 m0, s28, 0
  s_nop 0
  buffer_load_dwordx4 v28, s[8:11], s27 offen lds
  s_add_u32 m0, s28, 4096
  s_add_u32 s27, s27, 40960
  buffer_load_dwordx4 v28, s[8:11], s27 offen lds
  s_add_u32 m0, s28, 8192
  s_add_u32 s27, s27, 40960
  buffer_load_dwordx4 v28, s[8:11], s27 offen lds
  s_add_u32 m0, s28, 12288
  s_add_u32 s27, s27, 40960
  buffer_load_dwordx4 v28, s[8:11], s27 offen lds
  s_cmp_ge_u32 s67, 2
  s_cbranch_scc1 H_NX1
  s_add_u32 m0, s28, 16384
  s_add_u32 s27, s27, 40960
  buffer_load_dwordx4 v28, s[8:11], s27 offen lds
H_NX1:
  s_add_u32 s35, s35, 128
  v_mov_b32 v5, 0
  v_lshlrev_b32 v6, 2, v1
  v_cmp_gt_u32 vcc, 16, v1
  s_nop 1
  v_cndmask_b32 v6, v17, v6, vcc
  s_lshl_b32 s27, s65, 4
  s_add_u32 s27, s27, s66
  s_lshl_b32 s27, s27, 6
  s_mov_b32 s44, s90
  s_mov_b32 s45, s91
  s_mov_b32 s46, 256
  s_mov_b32 s47, 0x00020000
  s_add_u32 s48, s92, 8388608
  s_addc_u32 s49, s93, 0
  s_mov_b32 s50, 16384
  s_mov_b32 s51, 0x00020000
  s_cmp_lg_u32 s67, 0
  s_cbranch_scc1 H_NOINIT
  s_cmp_lg_u32 s2, 0
  s_cbranch_scc1 H_NONONCE
  s_memrealtime s[100:101]
  s_waitcnt lgkmcnt(0)
  s_lshl_b32 s100, s100, 3
  s_or_b32 s100, s100, 1
  v_mov_b32 v7, s100
  buffer_store_dword v7, v12, s[44:47], 0 offen sc1
H_NONONCE:
  buffer_store_dword v5, v6, s[48:51], s27 offen sc1
H_NOINIT:
  v_mov_b32 v52, 0x3f80
  v_mov_b32 v53, 0
  v_mov_b32 v54, 0
  v_mov_b32 v55, 0
  v_add_u32 v6, s69, v4
  v_add_u32 v7, 71680, v6
  s_not_b64 exec, s[70:71]
  ds_write_b128 v6, v[52:55] offset:0
  ds_write_b128 v6, v[52:55] offset:35840
  ds_write_b128 v7, v[52:55] offset:0
  ds_write_b128 v6, v[52:55] offset:1024
  ds_write_b128 v6, v[52:55] offset:36864
  ds_write_b128 v7, v[52:55] offset:1024
  s_not_b64 exec, s[4:5]
  ds_write_b128 v6, v[52:55] offset:2048
  ds_write_b128 v6, v[52:55] offset:37888
  ds_write_b128 v7, v[52:55] offset:2048
  ds_write_b128 v6, v[52:55] offset:3072
  ds_write_b128 v6, v[52:55] offset:38912
  ds_write_b128 v7, v[52:55] offset:3072
  s_mov_b64 exec, -1
  s_add_u32 m0, s33, s69
  s_mov_b64 exec, s[70:71]
  buffer_load_dwordx4 v45, s[12:15], s41 offen offset:0 lds
  buffer_load_dwordx4 v46, s[12:15], s41 offen offset:1024 lds
  s_mov_b64 exec, s[4:5]
  buffer_load_dwordx4 v47, s[12:15], s41 offen offset:2048 lds
  buffer_load_dwordx4 v48, s[12:15], s41 offen offset:3072 lds
  s_mov_b64 exec, -1
  s_add_u32 s41, s41, 245760
  s_add_u32 s28, s33, s68
  s_mov_b32 s27, s35
  s_add_u32 m0, s28, 0
  s_nop 0
  buffer_load_dwordx4 v28, s[8:11], s27 offen lds
  s_add_u32 m0, s28, 4096
  s_add_u32 s27, s27, 40960
  buffer_load_dwordx4 v28, s[8:11], s27 offen lds
  s_add_u32 m0, s28, 8192
  s_add_u32 s27, s27, 40960
  buffer_load_dwordx4 v28, s[8:11], s27 offen lds
  s_add_u32 m0, s28, 12288
  s_add_u32 s27, s27, 40960
  buffer_load_dwordx4 v28, s[8:11], s27 offen lds
  s_cmp_ge_u32 s67, 2
  s_cbranch_scc1 H_NX2
  s_add_u32 m0, s28, 16384
  s_add_u32 s27, s27, 40960
  buffer_load_dwordx4 v28, s[8:11], s27 offen lds
H_NX2:
  s_add_u32 s35, s35, 128
  s_add_u32 s96, s92, 9437184
  s_addc_u32 s97, s93, 0
  s_mov_b32 s98, 32768
  s_mov_b32 s99, 0x00020000
  s_mov_b32 s16, s76
  s_mov_b32 s17, s77
  s_mov_b32 s18, 819200
  s_mov_b32 s19, 0x00020000
  s_mov_b32 s52, s92
  s_mov_b32 s53, s93
  s_mov_b32 s54, 2621440
  s_mov_b32 s55, 0x00020000
  s_mul_i32 s27, s2, 3200
  v_lshlrev_b32 v19, 7, v1
  v_add_u32 v5, s27, v19
  v_cmp_gt_u32 vcc, 25, v1
  s_nop 1
  v_cndmask_b32 v18, v17, v5, vcc
  s_lshl_b32 s27, s67, 13
  v_add_u32 v20, s27, v19
  v_add_u32 v5, 0, v1
  v_mul_u32_u24 v6, 205, v5
  v_lshrrev_b32 v6, 11, v6
  v_mul_u32_u24 v7, 10, v6
  v_sub_u32 v7, v5, v7
  v_bfe_u32 v5, v6, 2, 2
  v_lshlrev_b32 v5, 3, v5
  v_lshrrev_b32 v8, 4, v6
  v_lshl_add_u32 v5, v8, 2, v5
  v_and_b32 v6, 3, v6
  v_add_u32 v6, v6, v5
  v_mul_u32_u24 v6, 1280, v6
  v_lshl_add_u32 v32, v7, 4, v6
  v_add_u32 v5, 64, v1
  v_mul_u32_u24 v6, 205, v5
  v_lshrrev_b32 v6, 11, v6
  v_mul_u32_u24 v7, 10, v6
  v_sub_u32 v7, v5, v7
  v_bfe_u32 v5, v6, 2, 2
  v_lshlrev_b32 v5, 3, v5
  v_lshrrev_b32 v8, 4, v6
  v_lshl_add_u32 v5, v8, 2, v5
  v_and_b32 v6, 3, v6
  v_add_u32 v6, v6, v5
  v_mul_u32_u24 v6, 1280, v6
  v_lshl_add_u32 v33, v7, 4, v6
  v_subrev_u32 v33, 1024, v33
  v_add_u32 v5, 128, v1
  v_mul_u32_u24 v6, 205, v5
  v_lshrrev_b32 v6, 11, v6
  v_mul_u32_u24 v7, 10, v6
  v_sub_u32 v7, v5, v7
  v_bfe_u32 v5, v6, 2, 2
  v_lshlrev_b32 v5, 3, v5
  v_lshrrev_b32 v8, 4, v6
  v_lshl_add_u32 v5, v8, 2, v5
  v_and_b32 v6, 3, v6
  v_add_u32 v6, v6, v5
  v_mul_u32_u24 v6, 1280, v6
  v_lshl_add_u32 v34, v7, 4, v6
  v_subrev_u32 v34, 2048, v34
  v_add_u32 v5, 192, v1
  v_mul_u32_u24 v6, 205, v5
  v_lshrrev_b32 v6, 11, v6
  v_mul_u32_u24 v7, 10, v6
  v_sub_u32 v7, v5, v7
  v_bfe_u32 v5, v6, 2, 2
  v_lshlrev_b32 v5, 3, v5
  v_lshrrev_b32 v8, 4, v6
  v_lshl_add_u32 v5, v8, 2, v5
  v_and_b32 v6, 3, v6
  v_add_u32 v6, v6, v5
  v_mul_u32_u24 v6, 1280, v6
  v_lshl_add_u32 v35, v7, 4, v6
  v_subrev_u32 v35, 3072, v35
  v_add_u32 v5, 256, v1
  v_mul_u32_u24 v6, 205, v5
  v_lshrrev_b32 v6, 11, v6
  v_mul_u32_u24 v7, 10, v6
  v_sub_u32 v7, v5, v7
  v_bfe_u32 v5, v6, 2, 2
  v_lshlrev_b32 v5, 3, v5
  v_lshrrev_b32 v8, 4, v6
  v_lshl_add_u32 v5, v8, 2, v5
  v_and_b32 v6, 3, v6
  v_add_u32 v6, v6, v5
  v_mul_u32_u24 v6, 1280, v6
  v_lshl_add_u32 v36, v7, 4, v6
  s_lshr_b32 s27, s26, 4
  s_lshl_b32 s28, s25, 1
  s_add_u32 s27, s27, s28
  s_and_b32 s27, s27, 3
  s_lshl_b32 s27, s27, 6
  s_and_b32 s28, s25, 6
  s_add_u32 s27, s27, s28
  v_and_b32 v6, 7, v1
  v_lshlrev_b32 v6, 3, v6
  v_bfe_u32 v7, v1, 3, 1
  v_add3_u32 v6, v6, v7, s27
  v_lshlrev_b32 v6, 7, v6
  v_cmp_gt_u32 vcc, 16, v1
  s_nop 1
  v_cndmask_b32 v14, v17, v6, vcc
  s_lshr_b32 s27, s25, 2
  s_lshl_b32 s27, s27, 2
  s_lshr_b32 s28, s26, 3
  s_add_u32 s27, s27, s28
  s_mul_i32 s27, s27, 5
  s_lshr_b32 s27, s27, 2
  v_cmp_le_u32 vcc, 24, v1
  s_nop 1
  v_cndmask_b32 v6, 0, 1, vcc
  v_mul_u32_u24 v7, 24, v6
  v_sub_u32 v7, v1, v7
  v_add_u32 v6, s27, v6
  v_cmp_le_u32 vcc, 5, v6
  s_nop 1
  v_cndmask_b32 v8, 0, 1, vcc
  v_mul_u32_u24 v5, 5, v8
  v_sub_u32 v6, v6, v5
  v_mul_u32_u24 v5, 43, v7
  v_lshrrev_b32 v5, 8, v5
  v_lshl_add_u32 v8, v8, 2, v5
  v_mul_u32_u24 v5, 6, v5
  v_sub_u32 v7, v7, v5
  v_mul_u32_u24 v7, 5, v7
  v_add_u32 v7, v7, v6
  v_lshl_add_u32 v7, v7, 3, v8
  v_lshlrev_b32 v7, 7, v7
  v_cmp_gt_u32 vcc, 48, v1
  s_nop 1
  v_cndmask_b32 v15, v17, v7, vcc
  s_lshl_b32 s29, s2, 7
  s_lshl_b32 s27, s25, 5
  s_add_u32 s27, s27, s26
  s_mul_i32 s31, s27, 10240
  s_and_b32 s27, s25, 1
  s_lshl_b32 s27, s27, 1
  s_bfe_u32 s28, s26, 0x10002
  s_add_u32 s27, s27, s28
  s_lshl_b32 s27, s27, 7
  v_lshlrev_b32 v6, 9, v1
  v_add_u32 v13, s27, v6
  v_lshrrev_b32 v6, 3, v1
  v_bfe_u32 v5, v1, 4, 1
  v_lshlrev_b32 v5, 2, v5
  v_and_b32 v7, 7, v1
  v_xor_b32 v5, v5, v7
  v_mul_u32_u24 v7, 3072, v6
  v_lshl_add_u32 v37, v5, 4, v7
  v_bfe_u32 v5, v1, 1, 2
  v_xor_b32 v5, v5, v3
  v_and_b32 v7, 1, v1
  v_lshl_add_u32 v5, v5, 1, v7
  v_lshlrev_b32 v7, 12, v6
  v_lshl_add_u32 v41, v5, 4, v7
  v_add_u32 v38, 23552, v37
  v_add_u32 v42, 31744, v41
  v_add_u32 v39, 47104, v37
  v_add_u32 v43, 63488, v41
  v_add_u32 v40, 70656, v37
  v_add_u32 v44, 95232, v41
  s_mul_i32 s27, s26, 13
  s_lshr_b32 s27, s27, 6
  s_lshl_b32 s28, s27, 2
  s_sub_u32 s60, s26, s28
  s_and_b32 s60, s60, 0
  s_and_b32 s28, s25, 3
  s_mul_i32 s56, s28, 6
  s_add_u32 s56, s56, s27
  s_lshl_b32 s56, s56, 7
  s_mul_i32 s27, s60, 196608
  s_add_u32 s56, s56, s27
  s_mul_i32 s27, s67, 1572864
  s_add_u32 s56, s56, s27
  s_lshr_b32 s27, s26, 3
  s_and_b32 s64, s26, 7
  s_lshl_b32 s63, s28, 3
  s_add_u32 s63, s63, s64
  s_lshl_b32 s63, s63, 7
  s_add_u32 s64, s64, s27
  s_sub_u32 s27, s64, 6
  s_cmp_ge_u32 s64, 6
  s_cselect_b32 s64, s27, s64
  s_mov_b32 s64, 0
  s_mul_i32 s27, s64, 262144
  s_add_u32 s63, s63, s27
  s_mul_i32 s27, s67, 1572864
  s_add_u32 s63, s63, s27
  s_mul_i32 s65, s67, 24576
  s_mov_b32 s57, 98304
  s_mov_b32 s58, 1572864
  s_mov_b32 s61, 8
  s_mov_b32 s59, 0
  s_mov_b32 s20, s80
  s_mov_b32 s21, s81
  s_mov_b32 s22, 6291456
  s_mov_b32 s23, 0x00020000
  s_cmp_lt_u32 s2, 240
  s_cbranch_scc1 H_HASP3
  s_mov_b32 s20, s84
  s_mov_b32 s21, s85
  s_mov_b32 s56, s63
  s_mov_b32 s57, 131072
  s_mov_b32 s58, 1572864
  s_mov_b32 s60, s64
  s_mov_b32 s61, 6
  v_mov_b32 v37, v41
  v_mov_b32 v38, v42
  v_mov_b32 v39, v43
  v_mov_b32 v40, v44
  s_mov_b32 s59, 16384
H_HASP3:
  s_waitcnt vmcnt(8) lgkmcnt(0)
  s_mov_b32 s43, 0
H_P1:
  s_barrier
  s_add_u32 m0, s34, s69
  s_mov_b64 exec, s[70:71]
  buffer_load_dwordx4 v45, s[12:15], s41 offen offset:0 lds
  buffer_load_dwordx4 v46, s[12:15], s41 offen offset:1024 lds
  s_mov_b64 exec, s[4:5]
  buffer_load_dwordx4 v47, s[12:15], s41 offen offset:2048 lds
  buffer_load_dwordx4 v48, s[12:15], s41 offen offset:3072 lds
  s_mov_b64 exec, -1
  s_add_u32 s41, s41, 245760
  s_add_u32 s28, s34, s68
  s_mov_b32 s27, s35
  s_add_u32 m0, s28, 0
  s_nop 0
  buffer_load_dwordx4 v28, s[8:11], s27 offen lds
  s_add_u32 m0, s28, 4096
  s_add_u32 s27, s27, 40960
  buffer_load_dwordx4 v28, s[8:11], s27 offen lds
  s_add_u32 m0, s28, 8192
  s_add_u32 s27, s27, 40960
  buffer_load_dwordx4 v28, s[8:11], s27 offen lds
  s_add_u32 m0, s28, 12288
  s_add_u32 s27, s27, 40960
  buffer_load_dwordx4 v28, s[8:11], s27 offen lds
  s_cmp_ge_u32 s67, 2
  s_cbranch_scc1 H_NX3
  s_add_u32 m0, s28, 16384
  s_add_u32 s27, s27, 40960
  buffer_load_dwordx4 v28, s[8:11], s27 offen lds
H_NX3:
  s_add_u32 s35, s35, 128
  s_mov_b32 s28, s32
  s_mov_b32 s32, s33
  s_mov_b32 s33, s34
  s_mov_b32 s34, s28
  s_add_u32 s43, s43, 1
  s_waitcnt vmcnt(8)
  s_cmp_lt_u32 s43, 8
  s_cbranch_scc1 H_P1
  s_barrier
  s_add_u32 s43, s67, 12
  s_mul_i32 s41, s43, 40960
  s_add_u32 s41, s41, s42
  s_mul_i32 s35, s43, 5120
  s_add_u32 s35, s35, 46080
H_WO1:
  s_mov_b32 m0, s35
  s_add_u32 s43, s43, 4
  buffer_load_dwordx4 v32, s[16:19], s41 offen offset:0 lds
  buffer_load_dwordx4 v33, s[16:19], s41 offen offset:1024 lds
  buffer_load_dwordx4 v34, s[16:19], s41 offen offset:2048 lds
  buffer_load_dwordx4 v35, s[16:19], s41 offen offset:3072 lds
  s_add_u32 m0, s35, 4096
  s_add_u32 s35, s35, 20480
  buffer_load_dwordx4 v36, s[16:19], s41 offen lds
  s_add_u32 s41, s41, 163840
  s_cmp_lt_u32 s43, 20
  s_cbranch_scc1 H_WO1
  s_waitcnt vmcnt(10)
  s_barrier
  s_add_u32 s43, s67, 0
  s_mul_i32 s41, s43, 40960
  s_add_u32 s41, s41, s42
  s_mul_i32 s35, s43, 5120
  s_add_u32 s35, s35, 46080
H_WO2:
  s_mov_b32 m0, s35
  s_add_u32 s43, s43, 4
  buffer_load_dwordx4 v32, s[16:19], s41 offen offset:0 lds
  buffer_load_dwordx4 v33, s[16:19], s41 offen offset:1024 lds
  buffer_load_dwordx4 v34, s[16:19], s41 offen offset:2048 lds
  buffer_load_dwordx4 v35, s[16:19], s41 offen offset:3072 lds
  s_add_u32 m0, s35, 4096
  s_add_u32 s35, s35, 20480
  buffer_load_dwordx4 v36, s[16:19], s41 offen lds
  s_add_u32 s41, s41, 163840
  s_cmp_lt_u32 s43, 5
  s_cbranch_scc1 H_WO2
  s_barrier
  s_add_u32 s43, s67, 5
  s_mul_i32 s41, s43, 40960
  s_add_u32 s41, s41, s42
  s_mul_i32 s35, s43, 5120
  s_add_u32 s35, s35, 46080
H_WO3:
  s_mov_b32 m0, s35
  s_add_u32 s43, s43, 4
  buffer_load_dwordx4 v32, s[16:19], s41 offen offset:0 lds
  buffer_load_dwordx4 v33, s[16:19], s41 offen offset:1024 lds
  buffer_load_dwordx4 v34, s[16:19], s41 offen offset:2048 lds
  buffer_load_dwordx4 v35, s[16:19], s41 offen offset:3072 lds
  s_add_u32 m0, s35, 4096
  s_add_u32 s35, s35, 20480
  buffer_load_dwordx4 v36, s[16:19], s41 offen lds
  s_add_u32 s41, s41, 163840
  s_cmp_lt_u32 s43, 12
  s_cbranch_scc1 H_WO3
  s_barrier
  v_mov_b32 v8, 0
  s_mov_b32 s3, 0
NONCE:
  buffer_load_dword v24, v8, s[44:47], 0 offen sc1
  s_add_u32 s3, s3, 1
  s_waitcnt vmcnt(0)
  v_readfirstlane_b32 s30, v24
  s_nop 1
  s_cmp_lg_u32 s30, 0
  s_cbranch_scc1 NONCED
  s_cmp_lt_u32 s3, 0x20000
  s_cbranch_scc1 NONCE
NONCED:
  s_add_u32 s27, s30, 2
  v_mov_b32 v16, s27
  v_cmp_gt_u32 s[36:37], 16, v1
  s_barrier
  s_waitcnt vmcnt(0)
  s_barrier
  s_cmp_lg_u32 s67, 0
  s_cbranch_scc1 H_S1X
  buffer_store_dword v16, v12, s[96:99], s29 offen sc1
  s_mov_b32 s3, 0
  s_add_u32 s40, s30, 2
POLL_S1:
  buffer_load_dword v24, v14, s[96:99], 0 offen sc1
  s_add_u32 s3, s3, 1
  s_waitcnt vmcnt(0)
  v_subrev_u32 v24, s40, v24
  v_cmp_ge_u32 vcc, 2, v24
  s_nop 1
  s_orn2_b64 s[38:39], vcc, s[36:37]
  s_cmp_eq_u64 s[38:39], -1
  s_cbranch_scc1 POLLD_S1
  s_sleep 1
  s_cmp_lt_u32 s3, 0x20000
  s_cbranch_scc1 POLL_S1
POLLD_S1:
  buffer_load_dword v9, v19, s[52:55], s31 offen sc1
  s_mov_b64 exec, 0xffff
  s_add_u32 s31, s31, 8192
  buffer_load_dword v9, v19, s[52:55], s31 offen sc1
  s_mov_b64 exec, -1
H_S1X:
  s_barrier
  s_add_u32 s27, s30, 3
  v_mov_b32 v16, s27
  s_mov_b64 s[36:37], -1
  s_barrier
  s_add_u32 m0, s59, s65
  s_nop 0
  buffer_load_dwordx4 v37, s[20:23], s56 offen offset:0 lds
  buffer_load_dwordx4 v38, s[20:23], s56 offen offset:1024 lds
  buffer_load_dwordx4 v39, s[20:23], s56 offen offset:2048 lds
  buffer_load_dwordx4 v40, s[20:23], s56 offen offset:3072 lds
  s_add_u32 s56, s56, s57
  s_add_u32 m0, m0, 4096
  s_nop 0
  buffer_load_dwordx4 v37, s[20:23], s56 offen offset:0 lds
  buffer_load_dwordx4 v38, s[20:23], s56 offen offset:1024 lds
  buffer_load_dwordx4 v39, s[20:23], s56 offen offset:2048 lds
  buffer_load_dwordx4 v40, s[20:23], s56 offen offset:3072 lds
  s_add_u32 s56, s56, s57
  s_add_u32 s60, s60, 1
  s_cmp_eq_u32 s60, s61
  s_cselect_b32 s27, s58, 0
  s_cselect_b32 s60, 0, s60
  s_sub_u32 s56, s56, s27
  s_add_u32 s59, s59, 8192
  s_cmp_eq_u32 s59, 24576
  s_cselect_b32 s59, 0, s59
  s_barrier
  s_cmp_lg_u32 s67, 0
  s_cbranch_scc1 H_F2
  buffer_store_dword v16, v12, s[96:99], s29 offen sc1
H_F2:
  s_mov_b32 s43, 0
H_PRE:
  s_add_u32 m0, s59, s65
  s_nop 0
  buffer_load_dwordx4 v37, s[20:23], s56 offen offset:0 lds
  buffer_load_dwordx4 v38, s[20:23], s56 offen offset:1024 lds
  buffer_load_dwordx4 v39, s[20:23], s56 offen offset:2048 lds
  buffer_load_dwordx4 v40, s[20:23], s56 offen offset:3072 lds
  s_add_u32 s56, s56, s57
  s_add_u32 m0, m0, 4096
  s_nop 0
  buffer_load_dwordx4 v37, s[20:23], s56 offen offset:0 lds
  buffer_load_dwordx4 v38, s[20:23], s56 offen offset:1024 lds
  buffer_load_dwordx4 v39, s[20:23], s56 offen offset:2048 lds
  buffer_load_dwordx4 v40, s[20:23], s56 offen offset:3072 lds
  s_add_u32 s56, s56, s57
  s_add_u32 s60, s60, 1
  s_cmp_eq_u32 s60, s61
  s_cselect_b32 s27, s58, 0
  s_cselect_b32 s60, 0, s60
  s_sub_u32 s56, s56, s27
  s_add_u32 s59, s59, 8192
  s_cmp_eq_u32 s59, 24576
  s_cselect_b32 s59, 0, s59
  s_add_u32 s43, s43, 1
  s_cmp_lt_u32 s43, 2
  s_cbranch_scc1 H_PRE
  s_mov_b32 s3, 0
  s_add_u32 s40, s30, 3
POLL_S2:
  buffer_load_dword v24, v20, s[96:99], 0 offen sc1
  s_add_u32 s3, s3, 1
  s_waitcnt vmcnt(0)
  v_subrev_u32 v24, s40, v24
  v_cmp_ge_u32 vcc, 1, v24
  s_nop 1
  s_orn2_b64 s[38:39], vcc, s[36:37]
  s_cmp_eq_u64 s[38:39], -1
  s_cbranch_scc1 POLLD_S2
  s_sleep 1
  s_cmp_lt_u32 s3, 0x20000
  s_cbranch_scc1 POLL_S2
POLLD_S2:
  s_barrier
  s_add_u32 s27, s30, 4
  v_mov_b32 v16, s27
  v_cmp_gt_u32 s[36:37], 48, v1
  s_cmp_ge_u32 s2, 240
  s_cbranch_scc1 H_NOP3
  s_barrier
  s_mov_b32 s43, 1
H_P3:
  s_barrier
  s_cmp_lg_u32 s43, 6
  s_cbranch_scc1 H_P3A
  s_mov_b32 s20, s84
  s_mov_b32 s21, s85
  s_mov_b32 s56, s63
  s_mov_b32 s57, 131072
  s_mov_b32 s58, 1572864
  s_mov_b32 s60, s64
  s_mov_b32 s61, 6
  v_mov_b32 v37, v41
  v_mov_b32 v38, v42
  v_mov_b32 v39, v43
  v_mov_b32 v40, v44
H_P3A:
  s_add_u32 m0, s59, s65
  s_nop 0
  buffer_load_dwordx4 v37, s[20:23], s56 offen offset:0 lds
  buffer_load_dwordx4 v38, s[20:23], s56 offen offset:1024 lds
  buffer_load_dwordx4 v39, s[20:23], s56 offen offset:2048 lds
  buffer_load_dwordx4 v40, s[20:23], s56 offen offset:3072 lds
  s_add_u32 s56, s56, s57
  s_add_u32 m0, m0, 4096
  s_nop 0
  buffer_load_dwordx4 v37, s[20:23], s56 offen offset:0 lds
  buffer_load_dwordx4 v38, s[20:23], s56 offen offset:1024 lds
  buffer_load_dwordx4 v39, s[20:23], s56 offen offset:2048 lds
  buffer_load_dwordx4 v40, s[20:23], s56 offen offset:3072 lds
  s_add_u32 s56, s56, s57
  s_add_u32 s60, s60, 1
  s_cmp_eq_u32 s60, s61
  s_cselect_b32 s27, s58, 0
  s_cselect_b32 s60, 0, s60
  s_sub_u32 s56, s56, s27
  s_add_u32 s59, s59, 8192
  s_cmp_eq_u32 s59, 24576
  s_cselect_b32 s59, 0, s59
  s_add_u32 s43, s43, 1
  s_waitcnt vmcnt(8)
  s_cmp_lt_u32 s43, 9
  s_cbranch_scc1 H_P3
  s_barrier
  s_barrier
  s_cmp_lg_u32 s67, 0
  s_cbranch_scc1 H_F3
  buffer_store_dword v16, v12, s[96:99], s29 offen sc1
H_F3:
H_NOP3:
  s_waitcnt vmcnt(0)
  s_cmp_lg_u32 s67, 0
  s_cbranch_scc1 H_S3X
  s_mov_b32 s3, 0
  s_add_u32 s40, s30, 4
POLL_S3:
  buffer_load_dword v24, v15, s[96:99], 0 offen sc1
  s_add_u32 s3, s3, 1
  s_waitcnt vmcnt(0)
  v_subrev_u32 v24, s40, v24
  v_cmp_ge_u32 vcc, 0, v24
  s_nop 1
  s_orn2_b64 s[38:39], vcc, s[36:37]
  s_cmp_eq_u64 s[38:39], -1
  s_cbranch_scc1 POLLD_S3
  s_sleep 1
  s_cmp_lt_u32 s3, 0x20000
  s_cbranch_scc1 POLL_S3
POLLD_S3:
H_S3X:
  s_barrier
  s_barrier
  s_mov_b32 s43, 1
H_P4:
  s_barrier
  s_add_u32 m0, s59, s65
  s_nop 0
  buffer_load_dwordx4 v37, s[20:23], s56 offen offset:0 lds
  buffer_load_dwordx4 v38, s[20:23], s56 offen offset:1024 lds
  buffer_load_dwordx4 v39, s[20:23], s56 offen offset:2048 lds
  buffer_load_dwordx4 v40, s[20:23], s56 offen offset:3072 lds
  s_add_u32 s56, s56, s57
  s_add_u32 m0, m0, 4096
  s_nop 0
  buffer_load_dwordx4 v37, s[20:23], s56 offen offset:0 lds
  buffer_load_dwordx4 v38, s[20:23], s56 offen offset:1024 lds
  buffer_load_dwordx4 v39, s[20:23], s56 offen offset:2048 lds
  buffer_load_dwordx4 v40, s[20:23], s56 offen offset:3072 lds
  s_add_u32 s56, s56, s57
  s_add_u32 s60, s60, 1
  s_cmp_eq_u32 s60, s61
  s_cselect_b32 s27, s58, 0
  s_cselect_b32 s60, 0, s60
  s_sub_u32 s56, s56, s27
  s_add_u32 s59, s59, 8192
  s_cmp_eq_u32 s59, 24576
  s_cselect_b32 s59, 0, s59
  s_add_u32 s43, s43, 1
  s_waitcnt vmcnt(8)
  s_cmp_lt_u32 s43, 4
  s_cbranch_scc1 H_P4
  s_barrier
  s_waitcnt vmcnt(0)
  s_barrier
K_END:
  s_endpgm
.section .rodata,"a"
.p2align 6
.amdhsa_kernel sequential_preLN__sliding_local_dilated__mixer_token_mlp__prompt_kernel
  .amdhsa_next_free_vgpr 168
  .amdhsa_next_free_sgpr 102
  .amdhsa_accum_offset 168
  .amdhsa_group_segment_fixed_size 0
  .amdhsa_kernarg_size 88
  .amdhsa_user_sgpr_count 2
  .amdhsa_user_sgpr_kernarg_segment_ptr 1
  .amdhsa_system_sgpr_workgroup_id_x 1
.end_amdhsa_kernel
```
